```python
import torch

def _softmax(x, axis=-1):
    return torch.softmax(x, dim=axis)
def _gelu(x):
    return torch.nn.functional.gelu(x, approximate="tanh")
def _silu(x):
    return torch.nn.functional.silu(x)
def _sigmoid(x):
    return torch.sigmoid(x)
def _layernorm(x, axis=-1, eps=1e-5):
    m = x.mean(dim=axis, keepdim=True)
    v = x.var(dim=axis, keepdim=True, unbiased=False)
    return (x - m) / torch.sqrt(v + eps)
def _scatter_add(tgt, idx, src, axis=0):
    return tgt.clone().index_add_(axis, idx, src)
def _segment_sum(src, seg, n):
    out = torch.zeros((n,) + src.shape[1:], dtype=src.dtype)
    return out.index_add_(0, seg, src)
def _pad(x, pw):
    flat = tuple(v for pair in reversed(pw) for v in pair)
    return torch.nn.functional.pad(x, flat)

kernel_name = 'concat_heads__ssm_conv_s4d__ssm_conv_h3__prompt'

def setup_inputs():

    _w = (lambda a: (lambda t: t.to(torch.bfloat16) if t.is_floating_point() else t)(torch.as_tensor(a)))
    def _A_setup():
        Bsz, L, D, N = 1, 2048, 512, 128
        return {
            "u": _w((lambda *s: torch.randn(*s, dtype=torch.bfloat16) * 0.05)(Bsz, L, D)),
            "log_A_real": _w((lambda *s: torch.randn(*s, dtype=torch.bfloat16) * 3.2)(D, N) * 0.5),
            "A_imag": _w((lambda *s: torch.randn(*s, dtype=torch.bfloat16) * 0.1)(D, N) * 3.14),
            "C_real": _w((lambda *s: torch.randn(*s, dtype=torch.bfloat16) * 0.1)(D, N) / N ** 0.5),
            "C_imag": _w((lambda *s: torch.randn(*s, dtype=torch.bfloat16) * 0.1)(D, N) / N ** 0.5),
            "log_dt": _w((lambda *s: torch.randn(*s, dtype=torch.bfloat16) * 0.05)(D) * 0.5 - 4.0),
            "D_skip": _w((lambda *s: torch.randn(*s, dtype=torch.bfloat16) * 0.05)(D)),
        }
    _A_in = _A_setup()

    def _B_setup():
        B, S, D = 1, 2048, 512
        ks = 4
        return {
            "q": _w((lambda *s: torch.randn(*s, dtype=torch.bfloat16) * 0.05)(B, S, D)),
            "k": _w((lambda *s: torch.randn(*s, dtype=torch.bfloat16) * 0.4)(B, S, D)),
            "v": _w((lambda *s: torch.randn(*s, dtype=torch.bfloat16) * 0.2)(B, S, D)),
            "shift_k": _w((lambda *s: torch.randn(*s, dtype=torch.bfloat16) * 0.4)(D, ks) * 0.5),
            "ssm_k": _w((lambda *s: torch.randn(*s, dtype=torch.bfloat16) * 0.4)(D, S) * (1.0 / S ** 0.5)),
            "ssm_D": _w((lambda *s: torch.randn(*s, dtype=torch.bfloat16) * 0.2)(D)),
        }
    _B_in = _B_setup()

    return {
        "A_u": _A_in["u"],
        "A_log_A_real": _A_in["log_A_real"],
        "A_A_imag": _A_in["A_imag"],
        "A_C_real": _A_in["C_real"],
        "A_C_imag": _A_in["C_imag"],
        "A_log_dt": _A_in["log_dt"],
        "A_D_skip": _A_in["D_skip"],
        "B_q": _B_in["q"],
        "B_k": _B_in["k"],
        "B_v": _B_in["v"],
        "B_shift_k": _B_in["shift_k"],
        "B_ssm_k": _B_in["ssm_k"],
        "B_ssm_D": _B_in["ssm_D"],
    }

def reference(A_u, A_log_A_real, A_A_imag, A_C_real, A_C_imag, A_log_dt, A_D_skip, B_q, B_k, B_v, B_shift_k, B_ssm_k, B_ssm_D):
    def _A_ref(u, log_A_real, A_imag, C_real, C_imag, log_dt, D_skip):
        L = u.shape[1]
        dt = torch.exp(log_dt)
        A = -torch.exp(log_A_real) + 1j * A_imag
        C = (C_real + 1j * C_imag) * dt[:, None]
        pos = (lambda x, dt: x.to(dt))(torch.arange(L), log_dt.dtype)
        P = torch.exp((A * dt[:, None])[:, :, None] * pos[None, None, :])
        K = 2.0 * torch.einsum("dn,dnl->dl", C, P).real
        L2 = 2 * L
        u_t = (lambda x, *d: x.permute(*d))(u, 0, 2, 1)
        Kf = (lambda x, *a, **k: torch.fft.rfft(x.float(), *a, **k))(K, L2)
        Uf = (lambda x, *a, **k: torch.fft.rfft(x.float(), *a, **k))(u_t, L2)
        y = (lambda x, *a, **k: torch.fft.irfft(x, *a, **k).to(torch.bfloat16))(Uf * Kf[None, :, :], L2)[:, :, :L]
        y = (lambda x, *d: x.permute(*d))(y, 0, 2, 1)
        return y + u * D_skip[None, None, :]

    def _B_ref(q, k, v, shift_k, ssm_k, ssm_D):
        B, S, D = q.shape
        ks = shift_k.shape[-1]
        k_pad = _pad(k, ((0, 0), (ks - 1, 0), (0, 0)))
        k_shift = torch.zeros_like(k)
        for t in range(ks):
            k_shift = k_shift + k_pad[:, t:t + S, :] * shift_k[:, ks - 1 - t][None, None, :]
        kv = k_shift * v
        L = 2 * S
        kv_pad = _pad(kv, ((0, 0), (0, S), (0, 0)))
        kf_pad = _pad(ssm_k, ((0, 0), (0, S)))
        kv_f = (lambda x, axes=(-2,-1): torch.fft.rfft2(x.float(), dim=axes))(kv_pad[:, None, :, :], axes=(1, 2))
        kf_f = (lambda x, axes=(-2,-1): torch.fft.rfft2(x.float(), dim=axes))(kf_pad[:, None, :], axes=(1, 2))
        kf_f = (lambda x, *d: x.permute(*d))(kf_f, 1, 2, 0)
        y_f = kv_f * kf_f[None, :, :, :]
        y = (lambda x, s, axes=(-2,-1): torch.fft.irfft2(x, s=s, dim=axes).to(torch.bfloat16))(y_f, (1, L), axes=(1, 2))[:, 0, :S, :]
        y = y + kv * ssm_D[None, None, :]
        return q * y

    a = _A_ref(A_u, A_log_A_real, A_A_imag, A_C_real, A_C_imag, A_log_dt, A_D_skip)
    b = _B_ref(B_q, B_k, B_v, B_shift_k, B_ssm_k, B_ssm_D)
    return torch.concatenate([a, b], axis=-1)
```

```asm
; @launch kernel=prep_kernel grid=(1024,1,1) block=(256,1,1) lds=10496
; @launch kernel=conv_kernel grid=(256,1,1) block=(256,1,1) lds=157056
; @launch kernel=outp_kernel grid=(512,1,1) block=(256,1,1) lds=9216
.amdgcn_target "amdgcn-amd-amdhsa--gfx950"
.text
.globl prep_kernel
.p2align 8
.type prep_kernel,@function
prep_kernel:
s_cmp_ge_u32 s2, 1024
s_cbranch_scc1 P_end
s_cmp_ge_u32 s2, 512
s_cbranch_scc1 P_tjob
s_load_dwordx2 s[4:5], s[0:1], 8
s_load_dwordx2 s[6:7], s[0:1], 16
s_load_dwordx2 s[8:9], s[0:1], 24
s_load_dwordx2 s[10:11], s[0:1], 32
s_load_dwordx2 s[12:13], s[0:1], 40
s_load_dwordx2 s[14:15], s[0:1], 120
s_waitcnt lgkmcnt(0)
s_mov_b32 s16, s4
s_mov_b32 s17, s5
s_mov_b32 s18, 131072
s_mov_b32 s19, 0x00020000
s_mov_b32 s20, s6
s_mov_b32 s21, s7
s_mov_b32 s22, 131072
s_mov_b32 s23, 0x00020000
s_mov_b32 s24, s8
s_mov_b32 s25, s9
s_mov_b32 s26, 131072
s_mov_b32 s27, 0x00020000
s_mov_b32 s28, s10
s_mov_b32 s29, s11
s_mov_b32 s30, 131072
s_mov_b32 s31, 0x00020000
s_mov_b32 s32, s12
s_mov_b32 s33, s13
s_mov_b32 s34, 1024
s_mov_b32 s35, 0x00020000
s_lshl_b32 s3, s2, 8
v_and_b32 v1, 127, v0
v_lshlrev_b32 v1, 1, v1
v_add_u32 v1, s3, v1
s_lshl_b32 s36, s2, 1
v_mov_b32 v2, s36
buffer_load_ushort v10, v1, s[16:19], 0 offen
buffer_load_ushort v11, v1, s[20:23], 0 offen
buffer_load_ushort v12, v1, s[24:27], 0 offen
buffer_load_ushort v13, v1, s[28:31], 0 offen
buffer_load_ushort v14, v2, s[32:35], 0 offen
s_waitcnt vmcnt(0)
v_lshlrev_b32 v10, 16, v10
v_lshlrev_b32 v11, 16, v11
v_lshlrev_b32 v12, 16, v12
v_lshlrev_b32 v13, 16, v13
v_lshlrev_b32 v14, 16, v14
v_mul_f32 v14, 0x3fb8aa3b, v14
v_mul_f32 v10, 0x3fb8aa3b, v10
v_exp_f32 v14, v14
v_exp_f32 v10, v10
s_nop 1
v_cvt_pk_bf16_f32 v15, v14, v10
v_lshlrev_b32 v14, 16, v15
v_and_b32 v10, 0xffff0000, v15
v_mul_f32 v10, v10, v14
v_mul_f32 v20, 0xbfb8aa3b, v10
v_mul_f32 v11, v11, v14
v_mul_f32 v21, 0x3e22f983, v11
v_mul_f32 v22, v12, v14
v_mul_f32 v22, 2.0, v22
v_mul_f32 v23, v13, v14
v_mul_f32 v23, 2.0, v23
v_and_b32 v3, 127, v0
v_lshlrev_b32 v3, 4, v3
ds_write_b128 v3, v[20:23]
s_waitcnt lgkmcnt(0)
s_barrier
v_lshrrev_b32 v4, 6, v0
s_nop 0
v_readfirstlane_b32 s40, v4
s_lshl_b32 s41, 1, s40
s_cmp_eq_u32 s40, 0
s_cselect_b32 s42, 0, 8
v_and_b32 v5, 15, v0
v_bfe_u32 v6, v0, 4, 2
v_add_u32 v7, s42, v5
v_lshlrev_b32 v7, 4, v7
v_mul_lo_u32 v7, v7, s41
v_cvt_f32_u32 v7, v7
v_mul_lo_u32 v8, v5, s41
v_cvt_f32_u32 v8, v8
v_lshlrev_b32 v9, 4, v6
v_mov_b32 v40, 0
v_mov_b32 v41, 0
v_mov_b32 v42, 0
v_mov_b32 v43, 0
ds_read_b128 v[20:23], v9 offset:0
s_waitcnt lgkmcnt(0)
v_mul_f32 v24, v20, v7
v_mul_f32 v25, v21, v7
v_mul_f32 v30, v20, v8
v_mul_f32 v31, v21, v8
v_exp_f32 v24, v24
v_fract_f32 v25, v25
v_exp_f32 v30, v30
v_fract_f32 v31, v31
v_cos_f32 v26, v25
v_sin_f32 v27, v25
v_cos_f32 v32, v31
v_sin_f32 v33, v31
s_nop 0
v_mul_f32 v28, v22, v26
v_mul_f32 v29, v22, v27
v_fma_f32 v28, -v23, v27, v28
v_fma_f32 v29, v23, v26, v29
v_mul_f32 v28, v24, v28
v_mul_f32 v29, v24, v29
v_sub_f32 v29, 0, v29
v_mul_f32 v32, v30, v32
v_mul_f32 v33, v30, v33
s_nop 1
v_mfma_f32_16x16x4_f32 v[40:43], v28, v32, v[40:43]
v_mfma_f32_16x16x4_f32 v[40:43], v29, v33, v[40:43]
ds_read_b128 v[20:23], v9 offset:64
s_waitcnt lgkmcnt(0)
v_mul_f32 v24, v20, v7
v_mul_f32 v25, v21, v7
v_mul_f32 v30, v20, v8
v_mul_f32 v31, v21, v8
v_exp_f32 v24, v24
v_fract_f32 v25, v25
v_exp_f32 v30, v30
v_fract_f32 v31, v31
v_cos_f32 v26, v25
v_sin_f32 v27, v25
v_cos_f32 v32, v31
v_sin_f32 v33, v31
s_nop 0
v_mul_f32 v28, v22, v26
v_mul_f32 v29, v22, v27
v_fma_f32 v28, -v23, v27, v28
v_fma_f32 v29, v23, v26, v29
v_mul_f32 v28, v24, v28
v_mul_f32 v29, v24, v29
v_sub_f32 v29, 0, v29
v_mul_f32 v32, v30, v32
v_mul_f32 v33, v30, v33
s_nop 1
v_mfma_f32_16x16x4_f32 v[40:43], v28, v32, v[40:43]
v_mfma_f32_16x16x4_f32 v[40:43], v29, v33, v[40:43]
ds_read_b128 v[20:23], v9 offset:128
s_waitcnt lgkmcnt(0)
v_mul_f32 v24, v20, v7
v_mul_f32 v25, v21, v7
v_mul_f32 v30, v20, v8
v_mul_f32 v31, v21, v8
v_exp_f32 v24, v24
v_fract_f32 v25, v25
v_exp_f32 v30, v30
v_fract_f32 v31, v31
v_cos_f32 v26, v25
v_sin_f32 v27, v25
v_cos_f32 v32, v31
v_sin_f32 v33, v31
s_nop 0
v_mul_f32 v28, v22, v26
v_mul_f32 v29, v22, v27
v_fma_f32 v28, -v23, v27, v28
v_fma_f32 v29, v23, v26, v29
v_mul_f32 v28, v24, v28
v_mul_f32 v29, v24, v29
v_sub_f32 v29, 0, v29
v_mul_f32 v32, v30, v32
v_mul_f32 v33, v30, v33
s_nop 1
v_mfma_f32_16x16x4_f32 v[40:43], v28, v32, v[40:43]
v_mfma_f32_16x16x4_f32 v[40:43], v29, v33, v[40:43]
ds_read_b128 v[20:23], v9 offset:192
s_waitcnt lgkmcnt(0)
v_mul_f32 v24, v20, v7
v_mul_f32 v25, v21, v7
v_mul_f32 v30, v20, v8
v_mul_f32 v31, v21, v8
v_exp_f32 v24, v24
v_fract_f32 v25, v25
v_exp_f32 v30, v30
v_fract_f32 v31, v31
v_cos_f32 v26, v25
v_sin_f32 v27, v25
v_cos_f32 v32, v31
v_sin_f32 v33, v31
s_nop 0
v_mul_f32 v28, v22, v26
v_mul_f32 v29, v22, v27
v_fma_f32 v28, -v23, v27, v28
v_fma_f32 v29, v23, v26, v29
v_mul_f32 v28, v24, v28
v_mul_f32 v29, v24, v29
v_sub_f32 v29, 0, v29
v_mul_f32 v32, v30, v32
v_mul_f32 v33, v30, v33
s_nop 1
v_mfma_f32_16x16x4_f32 v[40:43], v28, v32, v[40:43]
v_mfma_f32_16x16x4_f32 v[40:43], v29, v33, v[40:43]
ds_read_b128 v[20:23], v9 offset:256
s_waitcnt lgkmcnt(0)
v_mul_f32 v24, v20, v7
v_mul_f32 v25, v21, v7
v_mul_f32 v30, v20, v8
v_mul_f32 v31, v21, v8
v_exp_f32 v24, v24
v_fract_f32 v25, v25
v_exp_f32 v30, v30
v_fract_f32 v31, v31
v_cos_f32 v26, v25
v_sin_f32 v27, v25
v_cos_f32 v32, v31
v_sin_f32 v33, v31
s_nop 0
v_mul_f32 v28, v22, v26
v_mul_f32 v29, v22, v27
v_fma_f32 v28, -v23, v27, v28
v_fma_f32 v29, v23, v26, v29
v_mul_f32 v28, v24, v28
v_mul_f32 v29, v24, v29
v_sub_f32 v29, 0, v29
v_mul_f32 v32, v30, v32
v_mul_f32 v33, v30, v33
s_nop 1
v_mfma_f32_16x16x4_f32 v[40:43], v28, v32, v[40:43]
v_mfma_f32_16x16x4_f32 v[40:43], v29, v33, v[40:43]
ds_read_b128 v[20:23], v9 offset:320
s_waitcnt lgkmcnt(0)
v_mul_f32 v24, v20, v7
v_mul_f32 v25, v21, v7
v_mul_f32 v30, v20, v8
v_mul_f32 v31, v21, v8
v_exp_f32 v24, v24
v_fract_f32 v25, v25
v_exp_f32 v30, v30
v_fract_f32 v31, v31
v_cos_f32 v26, v25
v_sin_f32 v27, v25
v_cos_f32 v32, v31
v_sin_f32 v33, v31
s_nop 0
v_mul_f32 v28, v22, v26
v_mul_f32 v29, v22, v27
v_fma_f32 v28, -v23, v27, v28
v_fma_f32 v29, v23, v26, v29
v_mul_f32 v28, v24, v28
v_mul_f32 v29, v24, v29
v_sub_f32 v29, 0, v29
v_mul_f32 v32, v30, v32
v_mul_f32 v33, v30, v33
s_nop 1
v_mfma_f32_16x16x4_f32 v[40:43], v28, v32, v[40:43]
v_mfma_f32_16x16x4_f32 v[40:43], v29, v33, v[40:43]
ds_read_b128 v[20:23], v9 offset:384
s_waitcnt lgkmcnt(0)
v_mul_f32 v24, v20, v7
v_mul_f32 v25, v21, v7
v_mul_f32 v30, v20, v8
v_mul_f32 v31, v21, v8
v_exp_f32 v24, v24
v_fract_f32 v25, v25
v_exp_f32 v30, v30
v_fract_f32 v31, v31
v_cos_f32 v26, v25
v_sin_f32 v27, v25
v_cos_f32 v32, v31
v_sin_f32 v33, v31
s_nop 0
v_mul_f32 v28, v22, v26
v_mul_f32 v29, v22, v27
v_fma_f32 v28, -v23, v27, v28
v_fma_f32 v29, v23, v26, v29
v_mul_f32 v28, v24, v28
v_mul_f32 v29, v24, v29
v_sub_f32 v29, 0, v29
v_mul_f32 v32, v30, v32
v_mul_f32 v33, v30, v33
s_nop 1
v_mfma_f32_16x16x4_f32 v[40:43], v28, v32, v[40:43]
v_mfma_f32_16x16x4_f32 v[40:43], v29, v33, v[40:43]
ds_read_b128 v[20:23], v9 offset:448
s_waitcnt lgkmcnt(0)
v_mul_f32 v24, v20, v7
v_mul_f32 v25, v21, v7
v_mul_f32 v30, v20, v8
v_mul_f32 v31, v21, v8
v_exp_f32 v24, v24
v_fract_f32 v25, v25
v_exp_f32 v30, v30
v_fract_f32 v31, v31
v_cos_f32 v26, v25
v_sin_f32 v27, v25
v_cos_f32 v32, v31
v_sin_f32 v33, v31
s_nop 0
v_mul_f32 v28, v22, v26
v_mul_f32 v29, v22, v27
v_fma_f32 v28, -v23, v27, v28
v_fma_f32 v29, v23, v26, v29
v_mul_f32 v28, v24, v28
v_mul_f32 v29, v24, v29
v_sub_f32 v29, 0, v29
v_mul_f32 v32, v30, v32
v_mul_f32 v33, v30, v33
s_nop 1
v_mfma_f32_16x16x4_f32 v[40:43], v28, v32, v[40:43]
v_mfma_f32_16x16x4_f32 v[40:43], v29, v33, v[40:43]
ds_read_b128 v[20:23], v9 offset:512
s_waitcnt lgkmcnt(0)
v_mul_f32 v24, v20, v7
v_mul_f32 v25, v21, v7
v_mul_f32 v30, v20, v8
v_mul_f32 v31, v21, v8
v_exp_f32 v24, v24
v_fract_f32 v25, v25
v_exp_f32 v30, v30
v_fract_f32 v31, v31
v_cos_f32 v26, v25
v_sin_f32 v27, v25
v_cos_f32 v32, v31
v_sin_f32 v33, v31
s_nop 0
v_mul_f32 v28, v22, v26
v_mul_f32 v29, v22, v27
v_fma_f32 v28, -v23, v27, v28
v_fma_f32 v29, v23, v26, v29
v_mul_f32 v28, v24, v28
v_mul_f32 v29, v24, v29
v_sub_f32 v29, 0, v29
v_mul_f32 v32, v30, v32
v_mul_f32 v33, v30, v33
s_nop 1
v_mfma_f32_16x16x4_f32 v[40:43], v28, v32, v[40:43]
v_mfma_f32_16x16x4_f32 v[40:43], v29, v33, v[40:43]
ds_read_b128 v[20:23], v9 offset:576
s_waitcnt lgkmcnt(0)
v_mul_f32 v24, v20, v7
v_mul_f32 v25, v21, v7
v_mul_f32 v30, v20, v8
v_mul_f32 v31, v21, v8
v_exp_f32 v24, v24
v_fract_f32 v25, v25
v_exp_f32 v30, v30
v_fract_f32 v31, v31
v_cos_f32 v26, v25
v_sin_f32 v27, v25
v_cos_f32 v32, v31
v_sin_f32 v33, v31
s_nop 0
v_mul_f32 v28, v22, v26
v_mul_f32 v29, v22, v27
v_fma_f32 v28, -v23, v27, v28
v_fma_f32 v29, v23, v26, v29
v_mul_f32 v28, v24, v28
v_mul_f32 v29, v24, v29
v_sub_f32 v29, 0, v29
v_mul_f32 v32, v30, v32
v_mul_f32 v33, v30, v33
s_nop 1
v_mfma_f32_16x16x4_f32 v[40:43], v28, v32, v[40:43]
v_mfma_f32_16x16x4_f32 v[40:43], v29, v33, v[40:43]
ds_read_b128 v[20:23], v9 offset:640
s_waitcnt lgkmcnt(0)
v_mul_f32 v24, v20, v7
v_mul_f32 v25, v21, v7
v_mul_f32 v30, v20, v8
v_mul_f32 v31, v21, v8
v_exp_f32 v24, v24
v_fract_f32 v25, v25
v_exp_f32 v30, v30
v_fract_f32 v31, v31
v_cos_f32 v26, v25
v_sin_f32 v27, v25
v_cos_f32 v32, v31
v_sin_f32 v33, v31
s_nop 0
v_mul_f32 v28, v22, v26
v_mul_f32 v29, v22, v27
v_fma_f32 v28, -v23, v27, v28
v_fma_f32 v29, v23, v26, v29
v_mul_f32 v28, v24, v28
v_mul_f32 v29, v24, v29
v_sub_f32 v29, 0, v29
v_mul_f32 v32, v30, v32
v_mul_f32 v33, v30, v33
s_nop 1
v_mfma_f32_16x16x4_f32 v[40:43], v28, v32, v[40:43]
v_mfma_f32_16x16x4_f32 v[40:43], v29, v33, v[40:43]
ds_read_b128 v[20:23], v9 offset:704
s_waitcnt lgkmcnt(0)
v_mul_f32 v24, v20, v7
v_mul_f32 v25, v21, v7
v_mul_f32 v30, v20, v8
v_mul_f32 v31, v21, v8
v_exp_f32 v24, v24
v_fract_f32 v25, v25
v_exp_f32 v30, v30
v_fract_f32 v31, v31
v_cos_f32 v26, v25
v_sin_f32 v27, v25
v_cos_f32 v32, v31
v_sin_f32 v33, v31
s_nop 0
v_mul_f32 v28, v22, v26
v_mul_f32 v29, v22, v27
v_fma_f32 v28, -v23, v27, v28
v_fma_f32 v29, v23, v26, v29
v_mul_f32 v28, v24, v28
v_mul_f32 v29, v24, v29
v_sub_f32 v29, 0, v29
v_mul_f32 v32, v30, v32
v_mul_f32 v33, v30, v33
s_nop 1
v_mfma_f32_16x16x4_f32 v[40:43], v28, v32, v[40:43]
v_mfma_f32_16x16x4_f32 v[40:43], v29, v33, v[40:43]
ds_read_b128 v[20:23], v9 offset:768
s_waitcnt lgkmcnt(0)
v_mul_f32 v24, v20, v7
v_mul_f32 v25, v21, v7
v_mul_f32 v30, v20, v8
v_mul_f32 v31, v21, v8
v_exp_f32 v24, v24
v_fract_f32 v25, v25
v_exp_f32 v30, v30
v_fract_f32 v31, v31
v_cos_f32 v26, v25
v_sin_f32 v27, v25
v_cos_f32 v32, v31
v_sin_f32 v33, v31
s_nop 0
v_mul_f32 v28, v22, v26
v_mul_f32 v29, v22, v27
v_fma_f32 v28, -v23, v27, v28
v_fma_f32 v29, v23, v26, v29
v_mul_f32 v28, v24, v28
v_mul_f32 v29, v24, v29
v_sub_f32 v29, 0, v29
v_mul_f32 v32, v30, v32
v_mul_f32 v33, v30, v33
s_nop 1
v_mfma_f32_16x16x4_f32 v[40:43], v28, v32, v[40:43]
v_mfma_f32_16x16x4_f32 v[40:43], v29, v33, v[40:43]
ds_read_b128 v[20:23], v9 offset:832
s_waitcnt lgkmcnt(0)
v_mul_f32 v24, v20, v7
v_mul_f32 v25, v21, v7
v_mul_f32 v30, v20, v8
v_mul_f32 v31, v21, v8
v_exp_f32 v24, v24
v_fract_f32 v25, v25
v_exp_f32 v30, v30
v_fract_f32 v31, v31
v_cos_f32 v26, v25
v_sin_f32 v27, v25
v_cos_f32 v32, v31
v_sin_f32 v33, v31
s_nop 0
v_mul_f32 v28, v22, v26
v_mul_f32 v29, v22, v27
v_fma_f32 v28, -v23, v27, v28
v_fma_f32 v29, v23, v26, v29
v_mul_f32 v28, v24, v28
v_mul_f32 v29, v24, v29
v_sub_f32 v29, 0, v29
v_mul_f32 v32, v30, v32
v_mul_f32 v33, v30, v33
s_nop 1
v_mfma_f32_16x16x4_f32 v[40:43], v28, v32, v[40:43]
v_mfma_f32_16x16x4_f32 v[40:43], v29, v33, v[40:43]
ds_read_b128 v[20:23], v9 offset:896
s_waitcnt lgkmcnt(0)
v_mul_f32 v24, v20, v7
v_mul_f32 v25, v21, v7
v_mul_f32 v30, v20, v8
v_mul_f32 v31, v21, v8
v_exp_f32 v24, v24
v_fract_f32 v25, v25
v_exp_f32 v30, v30
v_fract_f32 v31, v31
v_cos_f32 v26, v25
v_sin_f32 v27, v25
v_cos_f32 v32, v31
v_sin_f32 v33, v31
s_nop 0
v_mul_f32 v28, v22, v26
v_mul_f32 v29, v22, v27
v_fma_f32 v28, -v23, v27, v28
v_fma_f32 v29, v23, v26, v29
v_mul_f32 v28, v24, v28
v_mul_f32 v29, v24, v29
v_sub_f32 v29, 0, v29
v_mul_f32 v32, v30, v32
v_mul_f32 v33, v30, v33
s_nop 1
v_mfma_f32_16x16x4_f32 v[40:43], v28, v32, v[40:43]
v_mfma_f32_16x16x4_f32 v[40:43], v29, v33, v[40:43]
ds_read_b128 v[20:23], v9 offset:960
s_waitcnt lgkmcnt(0)
v_mul_f32 v24, v20, v7
v_mul_f32 v25, v21, v7
v_mul_f32 v30, v20, v8
v_mul_f32 v31, v21, v8
v_exp_f32 v24, v24
v_fract_f32 v25, v25
v_exp_f32 v30, v30
v_fract_f32 v31, v31
v_cos_f32 v26, v25
v_sin_f32 v27, v25
v_cos_f32 v32, v31
v_sin_f32 v33, v31
s_nop 0
v_mul_f32 v28, v22, v26
v_mul_f32 v29, v22, v27
v_fma_f32 v28, -v23, v27, v28
v_fma_f32 v29, v23, v26, v29
v_mul_f32 v28, v24, v28
v_mul_f32 v29, v24, v29
v_sub_f32 v29, 0, v29
v_mul_f32 v32, v30, v32
v_mul_f32 v33, v30, v33
s_nop 1
v_mfma_f32_16x16x4_f32 v[40:43], v28, v32, v[40:43]
v_mfma_f32_16x16x4_f32 v[40:43], v29, v33, v[40:43]
ds_read_b128 v[20:23], v9 offset:1024
s_waitcnt lgkmcnt(0)
v_mul_f32 v24, v20, v7
v_mul_f32 v25, v21, v7
v_mul_f32 v30, v20, v8
v_mul_f32 v31, v21, v8
v_exp_f32 v24, v24
v_fract_f32 v25, v25
v_exp_f32 v30, v30
v_fract_f32 v31, v31
v_cos_f32 v26, v25
v_sin_f32 v27, v25
v_cos_f32 v32, v31
v_sin_f32 v33, v31
s_nop 0
v_mul_f32 v28, v22, v26
v_mul_f32 v29, v22, v27
v_fma_f32 v28, -v23, v27, v28
v_fma_f32 v29, v23, v26, v29
v_mul_f32 v28, v24, v28
v_mul_f32 v29, v24, v29
v_sub_f32 v29, 0, v29
v_mul_f32 v32, v30, v32
v_mul_f32 v33, v30, v33
s_nop 1
v_mfma_f32_16x16x4_f32 v[40:43], v28, v32, v[40:43]
v_mfma_f32_16x16x4_f32 v[40:43], v29, v33, v[40:43]
ds_read_b128 v[20:23], v9 offset:1088
s_waitcnt lgkmcnt(0)
v_mul_f32 v24, v20, v7
v_mul_f32 v25, v21, v7
v_mul_f32 v30, v20, v8
v_mul_f32 v31, v21, v8
v_exp_f32 v24, v24
v_fract_f32 v25, v25
v_exp_f32 v30, v30
v_fract_f32 v31, v31
v_cos_f32 v26, v25
v_sin_f32 v27, v25
v_cos_f32 v32, v31
v_sin_f32 v33, v31
s_nop 0
v_mul_f32 v28, v22, v26
v_mul_f32 v29, v22, v27
v_fma_f32 v28, -v23, v27, v28
v_fma_f32 v29, v23, v26, v29
v_mul_f32 v28, v24, v28
v_mul_f32 v29, v24, v29
v_sub_f32 v29, 0, v29
v_mul_f32 v32, v30, v32
v_mul_f32 v33, v30, v33
s_nop 1
v_mfma_f32_16x16x4_f32 v[40:43], v28, v32, v[40:43]
v_mfma_f32_16x16x4_f32 v[40:43], v29, v33, v[40:43]
ds_read_b128 v[20:23], v9 offset:1152
s_waitcnt lgkmcnt(0)
v_mul_f32 v24, v20, v7
v_mul_f32 v25, v21, v7
v_mul_f32 v30, v20, v8
v_mul_f32 v31, v21, v8
v_exp_f32 v24, v24
v_fract_f32 v25, v25
v_exp_f32 v30, v30
v_fract_f32 v31, v31
v_cos_f32 v26, v25
v_sin_f32 v27, v25
v_cos_f32 v32, v31
v_sin_f32 v33, v31
s_nop 0
v_mul_f32 v28, v22, v26
v_mul_f32 v29, v22, v27
v_fma_f32 v28, -v23, v27, v28
v_fma_f32 v29, v23, v26, v29
v_mul_f32 v28, v24, v28
v_mul_f32 v29, v24, v29
v_sub_f32 v29, 0, v29
v_mul_f32 v32, v30, v32
v_mul_f32 v33, v30, v33
s_nop 1
v_mfma_f32_16x16x4_f32 v[40:43], v28, v32, v[40:43]
v_mfma_f32_16x16x4_f32 v[40:43], v29, v33, v[40:43]
ds_read_b128 v[20:23], v9 offset:1216
s_waitcnt lgkmcnt(0)
v_mul_f32 v24, v20, v7
v_mul_f32 v25, v21, v7
v_mul_f32 v30, v20, v8
v_mul_f32 v31, v21, v8
v_exp_f32 v24, v24
v_fract_f32 v25, v25
v_exp_f32 v30, v30
v_fract_f32 v31, v31
v_cos_f32 v26, v25
v_sin_f32 v27, v25
v_cos_f32 v32, v31
v_sin_f32 v33, v31
s_nop 0
v_mul_f32 v28, v22, v26
v_mul_f32 v29, v22, v27
v_fma_f32 v28, -v23, v27, v28
v_fma_f32 v29, v23, v26, v29
v_mul_f32 v28, v24, v28
v_mul_f32 v29, v24, v29
v_sub_f32 v29, 0, v29
v_mul_f32 v32, v30, v32
v_mul_f32 v33, v30, v33
s_nop 1
v_mfma_f32_16x16x4_f32 v[40:43], v28, v32, v[40:43]
v_mfma_f32_16x16x4_f32 v[40:43], v29, v33, v[40:43]
ds_read_b128 v[20:23], v9 offset:1280
s_waitcnt lgkmcnt(0)
v_mul_f32 v24, v20, v7
v_mul_f32 v25, v21, v7
v_mul_f32 v30, v20, v8
v_mul_f32 v31, v21, v8
v_exp_f32 v24, v24
v_fract_f32 v25, v25
v_exp_f32 v30, v30
v_fract_f32 v31, v31
v_cos_f32 v26, v25
v_sin_f32 v27, v25
v_cos_f32 v32, v31
v_sin_f32 v33, v31
s_nop 0
v_mul_f32 v28, v22, v26
v_mul_f32 v29, v22, v27
v_fma_f32 v28, -v23, v27, v28
v_fma_f32 v29, v23, v26, v29
v_mul_f32 v28, v24, v28
v_mul_f32 v29, v24, v29
v_sub_f32 v29, 0, v29
v_mul_f32 v32, v30, v32
v_mul_f32 v33, v30, v33
s_nop 1
v_mfma_f32_16x16x4_f32 v[40:43], v28, v32, v[40:43]
v_mfma_f32_16x16x4_f32 v[40:43], v29, v33, v[40:43]
ds_read_b128 v[20:23], v9 offset:1344
s_waitcnt lgkmcnt(0)
v_mul_f32 v24, v20, v7
v_mul_f32 v25, v21, v7
v_mul_f32 v30, v20, v8
v_mul_f32 v31, v21, v8
v_exp_f32 v24, v24
v_fract_f32 v25, v25
v_exp_f32 v30, v30
v_fract_f32 v31, v31
v_cos_f32 v26, v25
v_sin_f32 v27, v25
v_cos_f32 v32, v31
v_sin_f32 v33, v31
s_nop 0
v_mul_f32 v28, v22, v26
v_mul_f32 v29, v22, v27
v_fma_f32 v28, -v23, v27, v28
v_fma_f32 v29, v23, v26, v29
v_mul_f32 v28, v24, v28
v_mul_f32 v29, v24, v29
v_sub_f32 v29, 0, v29
v_mul_f32 v32, v30, v32
v_mul_f32 v33, v30, v33
s_nop 1
v_mfma_f32_16x16x4_f32 v[40:43], v28, v32, v[40:43]
v_mfma_f32_16x16x4_f32 v[40:43], v29, v33, v[40:43]
ds_read_b128 v[20:23], v9 offset:1408
s_waitcnt lgkmcnt(0)
v_mul_f32 v24, v20, v7
v_mul_f32 v25, v21, v7
v_mul_f32 v30, v20, v8
v_mul_f32 v31, v21, v8
v_exp_f32 v24, v24
v_fract_f32 v25, v25
v_exp_f32 v30, v30
v_fract_f32 v31, v31
v_cos_f32 v26, v25
v_sin_f32 v27, v25
v_cos_f32 v32, v31
v_sin_f32 v33, v31
s_nop 0
v_mul_f32 v28, v22, v26
v_mul_f32 v29, v22, v27
v_fma_f32 v28, -v23, v27, v28
v_fma_f32 v29, v23, v26, v29
v_mul_f32 v28, v24, v28
v_mul_f32 v29, v24, v29
v_sub_f32 v29, 0, v29
v_mul_f32 v32, v30, v32
v_mul_f32 v33, v30, v33
s_nop 1
v_mfma_f32_16x16x4_f32 v[40:43], v28, v32, v[40:43]
v_mfma_f32_16x16x4_f32 v[40:43], v29, v33, v[40:43]
ds_read_b128 v[20:23], v9 offset:1472
s_waitcnt lgkmcnt(0)
v_mul_f32 v24, v20, v7
v_mul_f32 v25, v21, v7
v_mul_f32 v30, v20, v8
v_mul_f32 v31, v21, v8
v_exp_f32 v24, v24
v_fract_f32 v25, v25
v_exp_f32 v30, v30
v_fract_f32 v31, v31
v_cos_f32 v26, v25
v_sin_f32 v27, v25
v_cos_f32 v32, v31
v_sin_f32 v33, v31
s_nop 0
v_mul_f32 v28, v22, v26
v_mul_f32 v29, v22, v27
v_fma_f32 v28, -v23, v27, v28
v_fma_f32 v29, v23, v26, v29
v_mul_f32 v28, v24, v28
v_mul_f32 v29, v24, v29
v_sub_f32 v29, 0, v29
v_mul_f32 v32, v30, v32
v_mul_f32 v33, v30, v33
s_nop 1
v_mfma_f32_16x16x4_f32 v[40:43], v28, v32, v[40:43]
v_mfma_f32_16x16x4_f32 v[40:43], v29, v33, v[40:43]
ds_read_b128 v[20:23], v9 offset:1536
s_waitcnt lgkmcnt(0)
v_mul_f32 v24, v20, v7
v_mul_f32 v25, v21, v7
v_mul_f32 v30, v20, v8
v_mul_f32 v31, v21, v8
v_exp_f32 v24, v24
v_fract_f32 v25, v25
v_exp_f32 v30, v30
v_fract_f32 v31, v31
v_cos_f32 v26, v25
v_sin_f32 v27, v25
v_cos_f32 v32, v31
v_sin_f32 v33, v31
s_nop 0
v_mul_f32 v28, v22, v26
v_mul_f32 v29, v22, v27
v_fma_f32 v28, -v23, v27, v28
v_fma_f32 v29, v23, v26, v29
v_mul_f32 v28, v24, v28
v_mul_f32 v29, v24, v29
v_sub_f32 v29, 0, v29
v_mul_f32 v32, v30, v32
v_mul_f32 v33, v30, v33
s_nop 1
v_mfma_f32_16x16x4_f32 v[40:43], v28, v32, v[40:43]
v_mfma_f32_16x16x4_f32 v[40:43], v29, v33, v[40:43]
ds_read_b128 v[20:23], v9 offset:1600
s_waitcnt lgkmcnt(0)
v_mul_f32 v24, v20, v7
v_mul_f32 v25, v21, v7
v_mul_f32 v30, v20, v8
v_mul_f32 v31, v21, v8
v_exp_f32 v24, v24
v_fract_f32 v25, v25
v_exp_f32 v30, v30
v_fract_f32 v31, v31
v_cos_f32 v26, v25
v_sin_f32 v27, v25
v_cos_f32 v32, v31
v_sin_f32 v33, v31
s_nop 0
v_mul_f32 v28, v22, v26
v_mul_f32 v29, v22, v27
v_fma_f32 v28, -v23, v27, v28
v_fma_f32 v29, v23, v26, v29
v_mul_f32 v28, v24, v28
v_mul_f32 v29, v24, v29
v_sub_f32 v29, 0, v29
v_mul_f32 v32, v30, v32
v_mul_f32 v33, v30, v33
s_nop 1
v_mfma_f32_16x16x4_f32 v[40:43], v28, v32, v[40:43]
v_mfma_f32_16x16x4_f32 v[40:43], v29, v33, v[40:43]
ds_read_b128 v[20:23], v9 offset:1664
s_waitcnt lgkmcnt(0)
v_mul_f32 v24, v20, v7
v_mul_f32 v25, v21, v7
v_mul_f32 v30, v20, v8
v_mul_f32 v31, v21, v8
v_exp_f32 v24, v24
v_fract_f32 v25, v25
v_exp_f32 v30, v30
v_fract_f32 v31, v31
v_cos_f32 v26, v25
v_sin_f32 v27, v25
v_cos_f32 v32, v31
v_sin_f32 v33, v31
s_nop 0
v_mul_f32 v28, v22, v26
v_mul_f32 v29, v22, v27
v_fma_f32 v28, -v23, v27, v28
v_fma_f32 v29, v23, v26, v29
v_mul_f32 v28, v24, v28
v_mul_f32 v29, v24, v29
v_sub_f32 v29, 0, v29
v_mul_f32 v32, v30, v32
v_mul_f32 v33, v30, v33
s_nop 1
v_mfma_f32_16x16x4_f32 v[40:43], v28, v32, v[40:43]
v_mfma_f32_16x16x4_f32 v[40:43], v29, v33, v[40:43]
ds_read_b128 v[20:23], v9 offset:1728
s_waitcnt lgkmcnt(0)
v_mul_f32 v24, v20, v7
v_mul_f32 v25, v21, v7
v_mul_f32 v30, v20, v8
v_mul_f32 v31, v21, v8
v_exp_f32 v24, v24
v_fract_f32 v25, v25
v_exp_f32 v30, v30
v_fract_f32 v31, v31
v_cos_f32 v26, v25
v_sin_f32 v27, v25
v_cos_f32 v32, v31
v_sin_f32 v33, v31
s_nop 0
v_mul_f32 v28, v22, v26
v_mul_f32 v29, v22, v27
v_fma_f32 v28, -v23, v27, v28
v_fma_f32 v29, v23, v26, v29
v_mul_f32 v28, v24, v28
v_mul_f32 v29, v24, v29
v_sub_f32 v29, 0, v29
v_mul_f32 v32, v30, v32
v_mul_f32 v33, v30, v33
s_nop 1
v_mfma_f32_16x16x4_f32 v[40:43], v28, v32, v[40:43]
v_mfma_f32_16x16x4_f32 v[40:43], v29, v33, v[40:43]
ds_read_b128 v[20:23], v9 offset:1792
s_waitcnt lgkmcnt(0)
v_mul_f32 v24, v20, v7
v_mul_f32 v25, v21, v7
v_mul_f32 v30, v20, v8
v_mul_f32 v31, v21, v8
v_exp_f32 v24, v24
v_fract_f32 v25, v25
v_exp_f32 v30, v30
v_fract_f32 v31, v31
v_cos_f32 v26, v25
v_sin_f32 v27, v25
v_cos_f32 v32, v31
v_sin_f32 v33, v31
s_nop 0
v_mul_f32 v28, v22, v26
v_mul_f32 v29, v22, v27
v_fma_f32 v28, -v23, v27, v28
v_fma_f32 v29, v23, v26, v29
v_mul_f32 v28, v24, v28
v_mul_f32 v29, v24, v29
v_sub_f32 v29, 0, v29
v_mul_f32 v32, v30, v32
v_mul_f32 v33, v30, v33
s_nop 1
v_mfma_f32_16x16x4_f32 v[40:43], v28, v32, v[40:43]
v_mfma_f32_16x16x4_f32 v[40:43], v29, v33, v[40:43]
ds_read_b128 v[20:23], v9 offset:1856
s_waitcnt lgkmcnt(0)
v_mul_f32 v24, v20, v7
v_mul_f32 v25, v21, v7
v_mul_f32 v30, v20, v8
v_mul_f32 v31, v21, v8
v_exp_f32 v24, v24
v_fract_f32 v25, v25
v_exp_f32 v30, v30
v_fract_f32 v31, v31
v_cos_f32 v26, v25
v_sin_f32 v27, v25
v_cos_f32 v32, v31
v_sin_f32 v33, v31
s_nop 0
v_mul_f32 v28, v22, v26
v_mul_f32 v29, v22, v27
v_fma_f32 v28, -v23, v27, v28
v_fma_f32 v29, v23, v26, v29
v_mul_f32 v28, v24, v28
v_mul_f32 v29, v24, v29
v_sub_f32 v29, 0, v29
v_mul_f32 v32, v30, v32
v_mul_f32 v33, v30, v33
s_nop 1
v_mfma_f32_16x16x4_f32 v[40:43], v28, v32, v[40:43]
v_mfma_f32_16x16x4_f32 v[40:43], v29, v33, v[40:43]
ds_read_b128 v[20:23], v9 offset:1920
s_waitcnt lgkmcnt(0)
v_mul_f32 v24, v20, v7
v_mul_f32 v25, v21, v7
v_mul_f32 v30, v20, v8
v_mul_f32 v31, v21, v8
v_exp_f32 v24, v24
v_fract_f32 v25, v25
v_exp_f32 v30, v30
v_fract_f32 v31, v31
v_cos_f32 v26, v25
v_sin_f32 v27, v25
v_cos_f32 v32, v31
v_sin_f32 v33, v31
s_nop 0
v_mul_f32 v28, v22, v26
v_mul_f32 v29, v22, v27
v_fma_f32 v28, -v23, v27, v28
v_fma_f32 v29, v23, v26, v29
v_mul_f32 v28, v24, v28
v_mul_f32 v29, v24, v29
v_sub_f32 v29, 0, v29
v_mul_f32 v32, v30, v32
v_mul_f32 v33, v30, v33
s_nop 1
v_mfma_f32_16x16x4_f32 v[40:43], v28, v32, v[40:43]
v_mfma_f32_16x16x4_f32 v[40:43], v29, v33, v[40:43]
ds_read_b128 v[20:23], v9 offset:1984
s_waitcnt lgkmcnt(0)
v_mul_f32 v24, v20, v7
v_mul_f32 v25, v21, v7
v_mul_f32 v30, v20, v8
v_mul_f32 v31, v21, v8
v_exp_f32 v24, v24
v_fract_f32 v25, v25
v_exp_f32 v30, v30
v_fract_f32 v31, v31
v_cos_f32 v26, v25
v_sin_f32 v27, v25
v_cos_f32 v32, v31
v_sin_f32 v33, v31
s_nop 0
v_mul_f32 v28, v22, v26
v_mul_f32 v29, v22, v27
v_fma_f32 v28, -v23, v27, v28
v_fma_f32 v29, v23, v26, v29
v_mul_f32 v28, v24, v28
v_mul_f32 v29, v24, v29
v_sub_f32 v29, 0, v29
v_mul_f32 v32, v30, v32
v_mul_f32 v33, v30, v33
s_nop 1
v_mfma_f32_16x16x4_f32 v[40:43], v28, v32, v[40:43]
v_mfma_f32_16x16x4_f32 v[40:43], v29, v33, v[40:43]
s_nop 15
v_lshlrev_b32 v10, 2, v6
v_add_u32 v10, 0, v10
v_add_u32 v10, s42, v10
v_lshlrev_b32 v10, 4, v10
v_add_u32 v10, v10, v5
v_mul_lo_u32 v10, v10, s41
v_cmp_ge_u32 vcc, 2048, v10
s_and_saveexec_b64 s[44:45], vcc
v_lshlrev_b32 v10, 2, v10
ds_write_b32 v10, v40 offset:2048
s_mov_b64 exec, s[44:45]
v_lshlrev_b32 v10, 2, v6
v_add_u32 v10, 1, v10
v_add_u32 v10, s42, v10
v_lshlrev_b32 v10, 4, v10
v_add_u32 v10, v10, v5
v_mul_lo_u32 v10, v10, s41
v_cmp_ge_u32 vcc, 2048, v10
s_and_saveexec_b64 s[44:45], vcc
v_lshlrev_b32 v10, 2, v10
ds_write_b32 v10, v41 offset:2048
s_mov_b64 exec, s[44:45]
v_lshlrev_b32 v10, 2, v6
v_add_u32 v10, 2, v10
v_add_u32 v10, s42, v10
v_lshlrev_b32 v10, 4, v10
v_add_u32 v10, v10, v5
v_mul_lo_u32 v10, v10, s41
v_cmp_ge_u32 vcc, 2048, v10
s_and_saveexec_b64 s[44:45], vcc
v_lshlrev_b32 v10, 2, v10
ds_write_b32 v10, v42 offset:2048
s_mov_b64 exec, s[44:45]
v_lshlrev_b32 v10, 2, v6
v_add_u32 v10, 3, v10
v_add_u32 v10, s42, v10
v_lshlrev_b32 v10, 4, v10
v_add_u32 v10, v10, v5
v_mul_lo_u32 v10, v10, s41
v_cmp_ge_u32 vcc, 2048, v10
s_and_saveexec_b64 s[44:45], vcc
v_lshlrev_b32 v10, 2, v10
ds_write_b32 v10, v43 offset:2048
s_mov_b64 exec, s[44:45]
s_waitcnt lgkmcnt(0)
s_barrier
v_lshlrev_b32 v10, 3, v0
v_add_u32 v10, 0, v10
v_cvt_f32_u32 v10, v10
v_bfe_u32 v11, v10, 16, 1
v_add_u32 v10, 0x7fff, v10
v_add_u32 v10, v10, v11
v_and_b32 v10, 0xffff0000, v10
v_cvt_u32_f32 v10, v10
v_lshlrev_b32 v10, 2, v10
ds_read_b32 v20, v10 offset:2048
v_lshlrev_b32 v10, 3, v0
v_add_u32 v10, 1, v10
v_cvt_f32_u32 v10, v10
v_bfe_u32 v11, v10, 16, 1
v_add_u32 v10, 0x7fff, v10
v_add_u32 v10, v10, v11
v_and_b32 v10, 0xffff0000, v10
v_cvt_u32_f32 v10, v10
v_lshlrev_b32 v10, 2, v10
ds_read_b32 v21, v10 offset:2048
v_lshlrev_b32 v10, 3, v0
v_add_u32 v10, 2, v10
v_cvt_f32_u32 v10, v10
v_bfe_u32 v11, v10, 16, 1
v_add_u32 v10, 0x7fff, v10
v_add_u32 v10, v10, v11
v_and_b32 v10, 0xffff0000, v10
v_cvt_u32_f32 v10, v10
v_lshlrev_b32 v10, 2, v10
ds_read_b32 v22, v10 offset:2048
v_lshlrev_b32 v10, 3, v0
v_add_u32 v10, 3, v10
v_cvt_f32_u32 v10, v10
v_bfe_u32 v11, v10, 16, 1
v_add_u32 v10, 0x7fff, v10
v_add_u32 v10, v10, v11
v_and_b32 v10, 0xffff0000, v10
v_cvt_u32_f32 v10, v10
v_lshlrev_b32 v10, 2, v10
ds_read_b32 v23, v10 offset:2048
v_lshlrev_b32 v10, 3, v0
v_add_u32 v10, 4, v10
v_cvt_f32_u32 v10, v10
v_bfe_u32 v11, v10, 16, 1
v_add_u32 v10, 0x7fff, v10
v_add_u32 v10, v10, v11
v_and_b32 v10, 0xffff0000, v10
v_cvt_u32_f32 v10, v10
v_lshlrev_b32 v10, 2, v10
ds_read_b32 v24, v10 offset:2048
v_lshlrev_b32 v10, 3, v0
v_add_u32 v10, 5, v10
v_cvt_f32_u32 v10, v10
v_bfe_u32 v11, v10, 16, 1
v_add_u32 v10, 0x7fff, v10
v_add_u32 v10, v10, v11
v_and_b32 v10, 0xffff0000, v10
v_cvt_u32_f32 v10, v10
v_lshlrev_b32 v10, 2, v10
ds_read_b32 v25, v10 offset:2048
v_lshlrev_b32 v10, 3, v0
v_add_u32 v10, 6, v10
v_cvt_f32_u32 v10, v10
v_bfe_u32 v11, v10, 16, 1
v_add_u32 v10, 0x7fff, v10
v_add_u32 v10, v10, v11
v_and_b32 v10, 0xffff0000, v10
v_cvt_u32_f32 v10, v10
v_lshlrev_b32 v10, 2, v10
ds_read_b32 v26, v10 offset:2048
v_lshlrev_b32 v10, 3, v0
v_add_u32 v10, 7, v10
v_cvt_f32_u32 v10, v10
v_bfe_u32 v11, v10, 16, 1
v_add_u32 v10, 0x7fff, v10
v_add_u32 v10, v10, v11
v_and_b32 v10, 0xffff0000, v10
v_cvt_u32_f32 v10, v10
v_lshlrev_b32 v10, 2, v10
ds_read_b32 v27, v10 offset:2048
s_waitcnt lgkmcnt(0)
v_cvt_pk_bf16_f32 v30, v20, v21
v_cvt_pk_bf16_f32 v31, v22, v23
v_cvt_pk_bf16_f32 v32, v24, v25
v_cvt_pk_bf16_f32 v33, v26, v27
s_add_u32 s14, s14, 4194304
s_addc_u32 s15, s15, 0
s_mov_b32 s48, s14
s_mov_b32 s49, s15
s_mov_b32 s50, 2097152
s_mov_b32 s51, 0x00020000
s_lshl_b32 s3, s2, 12
v_lshlrev_b32 v10, 4, v0
v_add_u32 v10, s3, v10
buffer_store_dwordx4 v[30:33], v10, s[48:51], 0 offen
s_branch P_end
P_tjob:
s_sub_u32 s3, s2, 512
s_lshr_b32 s20, s3, 8
s_and_b32 s21, s3, 255
s_lshr_b32 s22, s21, 3
s_and_b32 s23, s21, 7
s_lshl_b32 s22, s22, 6
s_lshl_b32 s23, s23, 6
s_load_dwordx2 s[4:5], s[0:1], 0
s_load_dwordx2 s[6:7], s[0:1], 64
s_load_dwordx2 s[8:9], s[0:1], 72
s_load_dwordx2 s[10:11], s[0:1], 80
s_load_dwordx2 s[14:15], s[0:1], 120
s_waitcnt lgkmcnt(0)
s_mov_b32 s24, s4
s_mov_b32 s25, s5
s_mov_b32 s26, 2097152
s_mov_b32 s27, 0x00020000
s_mov_b32 s28, s6
s_mov_b32 s29, s7
s_mov_b32 s30, 2097152
s_mov_b32 s31, 0x00020000
s_mov_b32 s32, s8
s_mov_b32 s33, s9
s_mov_b32 s34, 2097152
s_mov_b32 s35, 0x00020000
s_mov_b32 s36, s10
s_mov_b32 s37, s11
s_mov_b32 s38, 4096
s_mov_b32 s39, 0x00020000
s_mov_b32 s40, s14
s_mov_b32 s41, s15
s_mov_b32 s42, 4194304
s_mov_b32 s43, 0x00020000
v_lshrrev_b32 v1, 2, v0
v_and_b32 v2, 3, v0
v_add_u32 v3, s22, v1
v_lshlrev_b32 v3, 10, v3
v_lshlrev_b32 v4, 5, v2
v_add_u32 v3, v3, v4
s_lshl_b32 s44, s23, 1
v_add_u32 v3, s44, v3
s_cmp_eq_u32 s20, 0
s_cbranch_scc0 P_kv
buffer_load_dwordx4 v[16:19], v3, s[24:27], 0 offen
buffer_load_dwordx4 v[20:23], v3, s[24:27], 0 offen offset:16
s_waitcnt vmcnt(0)
s_branch P_tr
P_kv:
v_subrev_u32 v5, 0, v3
buffer_load_dwordx4 v[32:35], v5, s[28:31], 0 offen
buffer_load_dwordx4 v[36:39], v5, s[28:31], 0 offen offset:16
v_subrev_u32 v5, 1024, v3
buffer_load_dwordx4 v[40:43], v5, s[28:31], 0 offen
buffer_load_dwordx4 v[44:47], v5, s[28:31], 0 offen offset:16
v_subrev_u32 v5, 2048, v3
buffer_load_dwordx4 v[48:51], v5, s[28:31], 0 offen
buffer_load_dwordx4 v[52:55], v5, s[28:31], 0 offen offset:16
v_subrev_u32 v5, 3072, v3
buffer_load_dwordx4 v[56:59], v5, s[28:31], 0 offen
buffer_load_dwordx4 v[60:63], v5, s[28:31], 0 offen offset:16
buffer_load_dwordx4 v[64:67], v3, s[32:35], 0 offen
buffer_load_dwordx4 v[68:71], v3, s[32:35], 0 offen offset:16
v_lshlrev_b32 v5, 7, v2
s_lshl_b32 s44, s23, 3
v_add_u32 v5, s44, v5
buffer_load_dwordx4 v[72:75], v5, s[36:39], 0 offen offset:0
buffer_load_dwordx4 v[76:79], v5, s[36:39], 0 offen offset:16
buffer_load_dwordx4 v[80:83], v5, s[36:39], 0 offen offset:32
buffer_load_dwordx4 v[84:87], v5, s[36:39], 0 offen offset:48
buffer_load_dwordx4 v[88:91], v5, s[36:39], 0 offen offset:64
buffer_load_dwordx4 v[92:95], v5, s[36:39], 0 offen offset:80
buffer_load_dwordx4 v[96:99], v5, s[36:39], 0 offen offset:96
buffer_load_dwordx4 v[100:103], v5, s[36:39], 0 offen offset:112
s_waitcnt vmcnt(0)
v_lshlrev_b32 v110, 16, v72
v_and_b32 v111, 0xffff0000, v72
v_lshlrev_b32 v112, 16, v73
v_and_b32 v113, 0xffff0000, v73
v_lshlrev_b32 v104, 16, v32
v_lshlrev_b32 v105, 16, v40
v_lshlrev_b32 v106, 16, v48
v_lshlrev_b32 v107, 16, v56
v_lshlrev_b32 v108, 16, v64
v_mul_f32 v104, v104, v110
v_mul_f32 v105, v105, v111
v_mul_f32 v106, v106, v112
v_mul_f32 v107, v107, v113
v_cvt_pk_bf16_f32 v114, v104, v105
v_cvt_pk_bf16_f32 v115, v106, v107
v_lshlrev_b32 v104, 16, v114
v_and_b32 v105, 0xffff0000, v114
v_lshlrev_b32 v106, 16, v115
v_and_b32 v107, 0xffff0000, v115
v_add_f32 v107, v107, v106
v_cvt_pk_bf16_f32 v114, v107, v107
v_lshlrev_b32 v107, 16, v114
v_add_f32 v107, v107, v105
v_cvt_pk_bf16_f32 v114, v107, v107
v_lshlrev_b32 v107, 16, v114
v_add_f32 v107, v107, v104
v_cvt_pk_bf16_f32 v114, v107, v107
v_lshlrev_b32 v107, 16, v114
v_mul_f32 v116, v107, v108
v_lshlrev_b32 v110, 16, v74
v_and_b32 v111, 0xffff0000, v74
v_lshlrev_b32 v112, 16, v75
v_and_b32 v113, 0xffff0000, v75
v_and_b32 v104, 0xffff0000, v32
v_and_b32 v105, 0xffff0000, v40
v_and_b32 v106, 0xffff0000, v48
v_and_b32 v107, 0xffff0000, v56
v_and_b32 v108, 0xffff0000, v64
v_mul_f32 v104, v104, v110
v_mul_f32 v105, v105, v111
v_mul_f32 v106, v106, v112
v_mul_f32 v107, v107, v113
v_cvt_pk_bf16_f32 v114, v104, v105
v_cvt_pk_bf16_f32 v115, v106, v107
v_lshlrev_b32 v104, 16, v114
v_and_b32 v105, 0xffff0000, v114
v_lshlrev_b32 v106, 16, v115
v_and_b32 v107, 0xffff0000, v115
v_add_f32 v107, v107, v106
v_cvt_pk_bf16_f32 v114, v107, v107
v_lshlrev_b32 v107, 16, v114
v_add_f32 v107, v107, v105
v_cvt_pk_bf16_f32 v114, v107, v107
v_lshlrev_b32 v107, 16, v114
v_add_f32 v107, v107, v104
v_cvt_pk_bf16_f32 v114, v107, v107
v_lshlrev_b32 v107, 16, v114
v_mul_f32 v117, v107, v108
v_cvt_pk_bf16_f32 v16, v116, v117
v_lshlrev_b32 v110, 16, v76
v_and_b32 v111, 0xffff0000, v76
v_lshlrev_b32 v112, 16, v77
v_and_b32 v113, 0xffff0000, v77
v_lshlrev_b32 v104, 16, v33
v_lshlrev_b32 v105, 16, v41
v_lshlrev_b32 v106, 16, v49
v_lshlrev_b32 v107, 16, v57
v_lshlrev_b32 v108, 16, v65
v_mul_f32 v104, v104, v110
v_mul_f32 v105, v105, v111
v_mul_f32 v106, v106, v112
v_mul_f32 v107, v107, v113
v_cvt_pk_bf16_f32 v114, v104, v105
v_cvt_pk_bf16_f32 v115, v106, v107
v_lshlrev_b32 v104, 16, v114
v_and_b32 v105, 0xffff0000, v114
v_lshlrev_b32 v106, 16, v115
v_and_b32 v107, 0xffff0000, v115
v_add_f32 v107, v107, v106
v_cvt_pk_bf16_f32 v114, v107, v107
v_lshlrev_b32 v107, 16, v114
v_add_f32 v107, v107, v105
v_cvt_pk_bf16_f32 v114, v107, v107
v_lshlrev_b32 v107, 16, v114
v_add_f32 v107, v107, v104
v_cvt_pk_bf16_f32 v114, v107, v107
v_lshlrev_b32 v107, 16, v114
v_mul_f32 v116, v107, v108
v_lshlrev_b32 v110, 16, v78
v_and_b32 v111, 0xffff0000, v78
v_lshlrev_b32 v112, 16, v79
v_and_b32 v113, 0xffff0000, v79
v_and_b32 v104, 0xffff0000, v33
v_and_b32 v105, 0xffff0000, v41
v_and_b32 v106, 0xffff0000, v49
v_and_b32 v107, 0xffff0000, v57
v_and_b32 v108, 0xffff0000, v65
v_mul_f32 v104, v104, v110
v_mul_f32 v105, v105, v111
v_mul_f32 v106, v106, v112
v_mul_f32 v107, v107, v113
v_cvt_pk_bf16_f32 v114, v104, v105
v_cvt_pk_bf16_f32 v115, v106, v107
v_lshlrev_b32 v104, 16, v114
v_and_b32 v105, 0xffff0000, v114
v_lshlrev_b32 v106, 16, v115
v_and_b32 v107, 0xffff0000, v115
v_add_f32 v107, v107, v106
v_cvt_pk_bf16_f32 v114, v107, v107
v_lshlrev_b32 v107, 16, v114
v_add_f32 v107, v107, v105
v_cvt_pk_bf16_f32 v114, v107, v107
v_lshlrev_b32 v107, 16, v114
v_add_f32 v107, v107, v104
v_cvt_pk_bf16_f32 v114, v107, v107
v_lshlrev_b32 v107, 16, v114
v_mul_f32 v117, v107, v108
v_cvt_pk_bf16_f32 v17, v116, v117
v_lshlrev_b32 v110, 16, v80
v_and_b32 v111, 0xffff0000, v80
v_lshlrev_b32 v112, 16, v81
v_and_b32 v113, 0xffff0000, v81
v_lshlrev_b32 v104, 16, v34
v_lshlrev_b32 v105, 16, v42
v_lshlrev_b32 v106, 16, v50
v_lshlrev_b32 v107, 16, v58
v_lshlrev_b32 v108, 16, v66
v_mul_f32 v104, v104, v110
v_mul_f32 v105, v105, v111
v_mul_f32 v106, v106, v112
v_mul_f32 v107, v107, v113
v_cvt_pk_bf16_f32 v114, v104, v105
v_cvt_pk_bf16_f32 v115, v106, v107
v_lshlrev_b32 v104, 16, v114
v_and_b32 v105, 0xffff0000, v114
v_lshlrev_b32 v106, 16, v115
v_and_b32 v107, 0xffff0000, v115
v_add_f32 v107, v107, v106
v_cvt_pk_bf16_f32 v114, v107, v107
v_lshlrev_b32 v107, 16, v114
v_add_f32 v107, v107, v105
v_cvt_pk_bf16_f32 v114, v107, v107
v_lshlrev_b32 v107, 16, v114
v_add_f32 v107, v107, v104
v_cvt_pk_bf16_f32 v114, v107, v107
v_lshlrev_b32 v107, 16, v114
v_mul_f32 v116, v107, v108
v_lshlrev_b32 v110, 16, v82
v_and_b32 v111, 0xffff0000, v82
v_lshlrev_b32 v112, 16, v83
v_and_b32 v113, 0xffff0000, v83
v_and_b32 v104, 0xffff0000, v34
v_and_b32 v105, 0xffff0000, v42
v_and_b32 v106, 0xffff0000, v50
v_and_b32 v107, 0xffff0000, v58
v_and_b32 v108, 0xffff0000, v66
v_mul_f32 v104, v104, v110
v_mul_f32 v105, v105, v111
v_mul_f32 v106, v106, v112
v_mul_f32 v107, v107, v113
v_cvt_pk_bf16_f32 v114, v104, v105
v_cvt_pk_bf16_f32 v115, v106, v107
v_lshlrev_b32 v104, 16, v114
v_and_b32 v105, 0xffff0000, v114
v_lshlrev_b32 v106, 16, v115
v_and_b32 v107, 0xffff0000, v115
v_add_f32 v107, v107, v106
v_cvt_pk_bf16_f32 v114, v107, v107
v_lshlrev_b32 v107, 16, v114
v_add_f32 v107, v107, v105
v_cvt_pk_bf16_f32 v114, v107, v107
v_lshlrev_b32 v107, 16, v114
v_add_f32 v107, v107, v104
v_cvt_pk_bf16_f32 v114, v107, v107
v_lshlrev_b32 v107, 16, v114
v_mul_f32 v117, v107, v108
v_cvt_pk_bf16_f32 v18, v116, v117
v_lshlrev_b32 v110, 16, v84
v_and_b32 v111, 0xffff0000, v84
v_lshlrev_b32 v112, 16, v85
v_and_b32 v113, 0xffff0000, v85
v_lshlrev_b32 v104, 16, v35
v_lshlrev_b32 v105, 16, v43
v_lshlrev_b32 v106, 16, v51
v_lshlrev_b32 v107, 16, v59
v_lshlrev_b32 v108, 16, v67
v_mul_f32 v104, v104, v110
v_mul_f32 v105, v105, v111
v_mul_f32 v106, v106, v112
v_mul_f32 v107, v107, v113
v_cvt_pk_bf16_f32 v114, v104, v105
v_cvt_pk_bf16_f32 v115, v106, v107
v_lshlrev_b32 v104, 16, v114
v_and_b32 v105, 0xffff0000, v114
v_lshlrev_b32 v106, 16, v115
v_and_b32 v107, 0xffff0000, v115
v_add_f32 v107, v107, v106
v_cvt_pk_bf16_f32 v114, v107, v107
v_lshlrev_b32 v107, 16, v114
v_add_f32 v107, v107, v105
v_cvt_pk_bf16_f32 v114, v107, v107
v_lshlrev_b32 v107, 16, v114
v_add_f32 v107, v107, v104
v_cvt_pk_bf16_f32 v114, v107, v107
v_lshlrev_b32 v107, 16, v114
v_mul_f32 v116, v107, v108
v_lshlrev_b32 v110, 16, v86
v_and_b32 v111, 0xffff0000, v86
v_lshlrev_b32 v112, 16, v87
v_and_b32 v113, 0xffff0000, v87
v_and_b32 v104, 0xffff0000, v35
v_and_b32 v105, 0xffff0000, v43
v_and_b32 v106, 0xffff0000, v51
v_and_b32 v107, 0xffff0000, v59
v_and_b32 v108, 0xffff0000, v67
v_mul_f32 v104, v104, v110
v_mul_f32 v105, v105, v111
v_mul_f32 v106, v106, v112
v_mul_f32 v107, v107, v113
v_cvt_pk_bf16_f32 v114, v104, v105
v_cvt_pk_bf16_f32 v115, v106, v107
v_lshlrev_b32 v104, 16, v114
v_and_b32 v105, 0xffff0000, v114
v_lshlrev_b32 v106, 16, v115
v_and_b32 v107, 0xffff0000, v115
v_add_f32 v107, v107, v106
v_cvt_pk_bf16_f32 v114, v107, v107
v_lshlrev_b32 v107, 16, v114
v_add_f32 v107, v107, v105
v_cvt_pk_bf16_f32 v114, v107, v107
v_lshlrev_b32 v107, 16, v114
v_add_f32 v107, v107, v104
v_cvt_pk_bf16_f32 v114, v107, v107
v_lshlrev_b32 v107, 16, v114
v_mul_f32 v117, v107, v108
v_cvt_pk_bf16_f32 v19, v116, v117
v_lshlrev_b32 v110, 16, v88
v_and_b32 v111, 0xffff0000, v88
v_lshlrev_b32 v112, 16, v89
v_and_b32 v113, 0xffff0000, v89
v_lshlrev_b32 v104, 16, v36
v_lshlrev_b32 v105, 16, v44
v_lshlrev_b32 v106, 16, v52
v_lshlrev_b32 v107, 16, v60
v_lshlrev_b32 v108, 16, v68
v_mul_f32 v104, v104, v110
v_mul_f32 v105, v105, v111
v_mul_f32 v106, v106, v112
v_mul_f32 v107, v107, v113
v_cvt_pk_bf16_f32 v114, v104, v105
v_cvt_pk_bf16_f32 v115, v106, v107
v_lshlrev_b32 v104, 16, v114
v_and_b32 v105, 0xffff0000, v114
v_lshlrev_b32 v106, 16, v115
v_and_b32 v107, 0xffff0000, v115
v_add_f32 v107, v107, v106
v_cvt_pk_bf16_f32 v114, v107, v107
v_lshlrev_b32 v107, 16, v114
v_add_f32 v107, v107, v105
v_cvt_pk_bf16_f32 v114, v107, v107
v_lshlrev_b32 v107, 16, v114
v_add_f32 v107, v107, v104
v_cvt_pk_bf16_f32 v114, v107, v107
v_lshlrev_b32 v107, 16, v114
v_mul_f32 v116, v107, v108
v_lshlrev_b32 v110, 16, v90
v_and_b32 v111, 0xffff0000, v90
v_lshlrev_b32 v112, 16, v91
v_and_b32 v113, 0xffff0000, v91
v_and_b32 v104, 0xffff0000, v36
v_and_b32 v105, 0xffff0000, v44
v_and_b32 v106, 0xffff0000, v52
v_and_b32 v107, 0xffff0000, v60
v_and_b32 v108, 0xffff0000, v68
v_mul_f32 v104, v104, v110
v_mul_f32 v105, v105, v111
v_mul_f32 v106, v106, v112
v_mul_f32 v107, v107, v113
v_cvt_pk_bf16_f32 v114, v104, v105
v_cvt_pk_bf16_f32 v115, v106, v107
v_lshlrev_b32 v104, 16, v114
v_and_b32 v105, 0xffff0000, v114
v_lshlrev_b32 v106, 16, v115
v_and_b32 v107, 0xffff0000, v115
v_add_f32 v107, v107, v106
v_cvt_pk_bf16_f32 v114, v107, v107
v_lshlrev_b32 v107, 16, v114
v_add_f32 v107, v107, v105
v_cvt_pk_bf16_f32 v114, v107, v107
v_lshlrev_b32 v107, 16, v114
v_add_f32 v107, v107, v104
v_cvt_pk_bf16_f32 v114, v107, v107
v_lshlrev_b32 v107, 16, v114
v_mul_f32 v117, v107, v108
v_cvt_pk_bf16_f32 v20, v116, v117
v_lshlrev_b32 v110, 16, v92
v_and_b32 v111, 0xffff0000, v92
v_lshlrev_b32 v112, 16, v93
v_and_b32 v113, 0xffff0000, v93
v_lshlrev_b32 v104, 16, v37
v_lshlrev_b32 v105, 16, v45
v_lshlrev_b32 v106, 16, v53
v_lshlrev_b32 v107, 16, v61
v_lshlrev_b32 v108, 16, v69
v_mul_f32 v104, v104, v110
v_mul_f32 v105, v105, v111
v_mul_f32 v106, v106, v112
v_mul_f32 v107, v107, v113
v_cvt_pk_bf16_f32 v114, v104, v105
v_cvt_pk_bf16_f32 v115, v106, v107
v_lshlrev_b32 v104, 16, v114
v_and_b32 v105, 0xffff0000, v114
v_lshlrev_b32 v106, 16, v115
v_and_b32 v107, 0xffff0000, v115
v_add_f32 v107, v107, v106
v_cvt_pk_bf16_f32 v114, v107, v107
v_lshlrev_b32 v107, 16, v114
v_add_f32 v107, v107, v105
v_cvt_pk_bf16_f32 v114, v107, v107
v_lshlrev_b32 v107, 16, v114
v_add_f32 v107, v107, v104
v_cvt_pk_bf16_f32 v114, v107, v107
v_lshlrev_b32 v107, 16, v114
v_mul_f32 v116, v107, v108
v_lshlrev_b32 v110, 16, v94
v_and_b32 v111, 0xffff0000, v94
v_lshlrev_b32 v112, 16, v95
v_and_b32 v113, 0xffff0000, v95
v_and_b32 v104, 0xffff0000, v37
v_and_b32 v105, 0xffff0000, v45
v_and_b32 v106, 0xffff0000, v53
v_and_b32 v107, 0xffff0000, v61
v_and_b32 v108, 0xffff0000, v69
v_mul_f32 v104, v104, v110
v_mul_f32 v105, v105, v111
v_mul_f32 v106, v106, v112
v_mul_f32 v107, v107, v113
v_cvt_pk_bf16_f32 v114, v104, v105
v_cvt_pk_bf16_f32 v115, v106, v107
v_lshlrev_b32 v104, 16, v114
v_and_b32 v105, 0xffff0000, v114
v_lshlrev_b32 v106, 16, v115
v_and_b32 v107, 0xffff0000, v115
v_add_f32 v107, v107, v106
v_cvt_pk_bf16_f32 v114, v107, v107
v_lshlrev_b32 v107, 16, v114
v_add_f32 v107, v107, v105
v_cvt_pk_bf16_f32 v114, v107, v107
v_lshlrev_b32 v107, 16, v114
v_add_f32 v107, v107, v104
v_cvt_pk_bf16_f32 v114, v107, v107
v_lshlrev_b32 v107, 16, v114
v_mul_f32 v117, v107, v108
v_cvt_pk_bf16_f32 v21, v116, v117
v_lshlrev_b32 v110, 16, v96
v_and_b32 v111, 0xffff0000, v96
v_lshlrev_b32 v112, 16, v97
v_and_b32 v113, 0xffff0000, v97
v_lshlrev_b32 v104, 16, v38
v_lshlrev_b32 v105, 16, v46
v_lshlrev_b32 v106, 16, v54
v_lshlrev_b32 v107, 16, v62
v_lshlrev_b32 v108, 16, v70
v_mul_f32 v104, v104, v110
v_mul_f32 v105, v105, v111
v_mul_f32 v106, v106, v112
v_mul_f32 v107, v107, v113
v_cvt_pk_bf16_f32 v114, v104, v105
v_cvt_pk_bf16_f32 v115, v106, v107
v_lshlrev_b32 v104, 16, v114
v_and_b32 v105, 0xffff0000, v114
v_lshlrev_b32 v106, 16, v115
v_and_b32 v107, 0xffff0000, v115
v_add_f32 v107, v107, v106
v_cvt_pk_bf16_f32 v114, v107, v107
v_lshlrev_b32 v107, 16, v114
v_add_f32 v107, v107, v105
v_cvt_pk_bf16_f32 v114, v107, v107
v_lshlrev_b32 v107, 16, v114
v_add_f32 v107, v107, v104
v_cvt_pk_bf16_f32 v114, v107, v107
v_lshlrev_b32 v107, 16, v114
v_mul_f32 v116, v107, v108
v_lshlrev_b32 v110, 16, v98
v_and_b32 v111, 0xffff0000, v98
v_lshlrev_b32 v112, 16, v99
v_and_b32 v113, 0xffff0000, v99
v_and_b32 v104, 0xffff0000, v38
v_and_b32 v105, 0xffff0000, v46
v_and_b32 v106, 0xffff0000, v54
v_and_b32 v107, 0xffff0000, v62
v_and_b32 v108, 0xffff0000, v70
v_mul_f32 v104, v104, v110
v_mul_f32 v105, v105, v111
v_mul_f32 v106, v106, v112
v_mul_f32 v107, v107, v113
v_cvt_pk_bf16_f32 v114, v104, v105
v_cvt_pk_bf16_f32 v115, v106, v107
v_lshlrev_b32 v104, 16, v114
v_and_b32 v105, 0xffff0000, v114
v_lshlrev_b32 v106, 16, v115
v_and_b32 v107, 0xffff0000, v115
v_add_f32 v107, v107, v106
v_cvt_pk_bf16_f32 v114, v107, v107
v_lshlrev_b32 v107, 16, v114
v_add_f32 v107, v107, v105
v_cvt_pk_bf16_f32 v114, v107, v107
v_lshlrev_b32 v107, 16, v114
v_add_f32 v107, v107, v104
v_cvt_pk_bf16_f32 v114, v107, v107
v_lshlrev_b32 v107, 16, v114
v_mul_f32 v117, v107, v108
v_cvt_pk_bf16_f32 v22, v116, v117
v_lshlrev_b32 v110, 16, v100
v_and_b32 v111, 0xffff0000, v100
v_lshlrev_b32 v112, 16, v101
v_and_b32 v113, 0xffff0000, v101
v_lshlrev_b32 v104, 16, v39
v_lshlrev_b32 v105, 16, v47
v_lshlrev_b32 v106, 16, v55
v_lshlrev_b32 v107, 16, v63
v_lshlrev_b32 v108, 16, v71
v_mul_f32 v104, v104, v110
v_mul_f32 v105, v105, v111
v_mul_f32 v106, v106, v112
v_mul_f32 v107, v107, v113
v_cvt_pk_bf16_f32 v114, v104, v105
v_cvt_pk_bf16_f32 v115, v106, v107
v_lshlrev_b32 v104, 16, v114
v_and_b32 v105, 0xffff0000, v114
v_lshlrev_b32 v106, 16, v115
v_and_b32 v107, 0xffff0000, v115
v_add_f32 v107, v107, v106
v_cvt_pk_bf16_f32 v114, v107, v107
v_lshlrev_b32 v107, 16, v114
v_add_f32 v107, v107, v105
v_cvt_pk_bf16_f32 v114, v107, v107
v_lshlrev_b32 v107, 16, v114
v_add_f32 v107, v107, v104
v_cvt_pk_bf16_f32 v114, v107, v107
v_lshlrev_b32 v107, 16, v114
v_mul_f32 v116, v107, v108
v_lshlrev_b32 v110, 16, v102
v_and_b32 v111, 0xffff0000, v102
v_lshlrev_b32 v112, 16, v103
v_and_b32 v113, 0xffff0000, v103
v_and_b32 v104, 0xffff0000, v39
v_and_b32 v105, 0xffff0000, v47
v_and_b32 v106, 0xffff0000, v55
v_and_b32 v107, 0xffff0000, v63
v_and_b32 v108, 0xffff0000, v71
v_mul_f32 v104, v104, v110
v_mul_f32 v105, v105, v111
v_mul_f32 v106, v106, v112
v_mul_f32 v107, v107, v113
v_cvt_pk_bf16_f32 v114, v104, v105
v_cvt_pk_bf16_f32 v115, v106, v107
v_lshlrev_b32 v104, 16, v114
v_and_b32 v105, 0xffff0000, v114
v_lshlrev_b32 v106, 16, v115
v_and_b32 v107, 0xffff0000, v115
v_add_f32 v107, v107, v106
v_cvt_pk_bf16_f32 v114, v107, v107
v_lshlrev_b32 v107, 16, v114
v_add_f32 v107, v107, v105
v_cvt_pk_bf16_f32 v114, v107, v107
v_lshlrev_b32 v107, 16, v114
v_add_f32 v107, v107, v104
v_cvt_pk_bf16_f32 v114, v107, v107
v_lshlrev_b32 v107, 16, v114
v_mul_f32 v117, v107, v108
v_cvt_pk_bf16_f32 v23, v116, v117
P_tr:
v_mul_u32_u24 v5, 2304, v2
v_lshlrev_b32 v6, 1, v1
v_add_u32 v5, v5, v6
ds_write_b16 v5, v16 offset:0
ds_write_b16_d16_hi v5, v16 offset:144
ds_write_b16 v5, v17 offset:288
ds_write_b16_d16_hi v5, v17 offset:432
ds_write_b16 v5, v18 offset:576
ds_write_b16_d16_hi v5, v18 offset:720
ds_write_b16 v5, v19 offset:864
ds_write_b16_d16_hi v5, v19 offset:1008
ds_write_b16 v5, v20 offset:1152
ds_write_b16_d16_hi v5, v20 offset:1296
ds_write_b16 v5, v21 offset:1440
ds_write_b16_d16_hi v5, v21 offset:1584
ds_write_b16 v5, v22 offset:1728
ds_write_b16_d16_hi v5, v22 offset:1872
ds_write_b16 v5, v23 offset:2016
ds_write_b16_d16_hi v5, v23 offset:2160
s_waitcnt lgkmcnt(0)
s_barrier
v_mul_u32_u24 v5, 144, v1
v_lshlrev_b32 v6, 5, v2
v_add_u32 v5, v5, v6
ds_read_b128 v[16:19], v5
ds_read_b128 v[20:23], v5 offset:16
s_waitcnt lgkmcnt(0)
v_alignbit_b32 v24, v19, v19, 16
v_alignbit_b32 v25, v18, v18, 16
v_alignbit_b32 v26, v17, v17, 16
v_alignbit_b32 v27, v16, v16, 16
v_alignbit_b32 v28, v23, v23, 16
v_alignbit_b32 v29, v22, v22, 16
v_alignbit_b32 v30, v21, v21, 16
v_alignbit_b32 v31, v20, v20, 16
s_lshl_b32 s44, s20, 9
s_add_u32 s44, s44, s23
s_lshl_b32 s44, s44, 12
s_lshl_b32 s45, s22, 1
s_add_u32 s44, s44, s45
v_lshlrev_b32 v5, 12, v1
v_add_u32 v5, s44, v5
v_add_u32 v5, v5, v6
buffer_store_dwordx4 v[24:27], v5, s[40:43], 0 offen
buffer_store_dwordx4 v[28:31], v5, s[40:43], 0 offen offset:16
P_end:
s_endpgm
.globl conv_kernel
.p2align 8
.type conv_kernel,@function
conv_kernel:
s_cmp_ge_u32 s2, 256
s_cbranch_scc1 C_end
s_load_dwordx2 s[4:5], s[0:1], 88
s_load_dwordx2 s[6:7], s[0:1], 120
s_load_dwordx2 s[8:9], s[0:1], 48
s_load_dwordx2 s[10:11], s[0:1], 96
v_lshrrev_b32 v1, 6, v0
v_and_b32 v2, 63, v0
s_nop 0
v_readfirstlane_b32 s20, v1
s_lshl_b32 s21, s2, 2
s_add_u32 s21, s21, s20
s_waitcnt lgkmcnt(0)
s_cmp_lt_u32 s21, 512
s_cbranch_scc0 C_b
s_add_u32 s4, s6, 4194304
s_addc_u32 s5, s7, 0
s_mov_b32 s22, s21
s_branch C_j
C_b:
s_sub_u32 s22, s21, 512
s_mov_b32 s8, s10
s_mov_b32 s9, s11
C_j:
s_lshl_b32 s23, s22, 12
s_add_u32 s4, s4, s23
s_addc_u32 s5, s5, 0
s_mov_b32 s24, s4
s_mov_b32 s25, s5
s_mov_b32 s26, 4096
s_mov_b32 s27, 0x00020000
s_lshl_b32 s23, s21, 12
s_add_u32 s12, s6, s23
s_addc_u32 s13, s7, 0
s_mov_b32 s28, s12
s_mov_b32 s29, s13
s_mov_b32 s30, 4096
s_mov_b32 s31, 0x00020000
s_mov_b32 s32, s8
s_mov_b32 s33, s9
s_mov_b32 s34, 1024
s_mov_b32 s35, 0x00020000
s_mul_i32 s36, s20, 39264
s_lshl_b32 s37, s22, 1
v_mov_b32 v3, s37
buffer_load_ushort v4, v3, s[32:35], 0 offen
v_add_u32 v3, 4294967292, v2
v_lshlrev_b32 v3, 4, v3
buffer_load_dwordx4 v[16:19], v3, s[24:27], 0 offen
buffer_load_dwordx4 v[20:23], v3, s[24:27], 0 offen offset:16
v_add_u32 v3, 60, v2
v_lshlrev_b32 v3, 4, v3
buffer_load_dwordx4 v[24:27], v3, s[24:27], 0 offen
buffer_load_dwordx4 v[28:31], v3, s[24:27], 0 offen offset:16
v_add_u32 v3, 124, v2
v_lshlrev_b32 v3, 4, v3
buffer_load_dwordx4 v[32:35], v3, s[24:27], 0 offen
buffer_load_dwordx4 v[36:39], v3, s[24:27], 0 offen offset:16
v_add_u32 v3, 188, v2
v_lshlrev_b32 v3, 4, v3
buffer_load_dwordx4 v[40:43], v3, s[24:27], 0 offen
buffer_load_dwordx4 v[44:47], v3, s[24:27], 0 offen offset:16
v_add_u32 v3, 252, v2
v_lshlrev_b32 v3, 4, v3
buffer_load_dwordx4 v[48:51], v3, s[24:27], 0 offen
buffer_load_dwordx4 v[52:55], v3, s[24:27], 0 offen offset:16
v_lshlrev_b32 v3, 4, v2
buffer_load_dwordx4 v[56:59], v3, s[28:31], 0 offen offset:0
v_lshlrev_b32 v3, 4, v2
buffer_load_dwordx4 v[60:63], v3, s[28:31], 0 offen offset:1024
v_lshlrev_b32 v3, 4, v2
buffer_load_dwordx4 v[64:67], v3, s[28:31], 0 offen offset:2048
v_lshlrev_b32 v3, 4, v2
buffer_load_dwordx4 v[68:71], v3, s[28:31], 0 offen offset:3072
v_lshrrev_b32 v5, 2, v2
v_mul_u32_u24 v5, 80, v5
v_and_b32 v6, 3, v2
v_lshlrev_b32 v6, 4, v6
v_add_u32 v5, v5, v6
v_add_u32 v5, s36, v5
v_mov_b32 v8, 0
v_mov_b32 v9, 0
v_mov_b32 v10, 0
v_mov_b32 v11, 0
s_waitcnt vmcnt(0)
ds_write_b128 v5, v[56:59] offset:34128
ds_write_b128 v5, v[60:63] offset:35408
ds_write_b128 v5, v[64:67] offset:36688
ds_write_b128 v5, v[68:71] offset:37968
v_lshlrev_b32 v6, 4, v2
v_add_u32 v6, s36, v6
v_cmp_gt_u32 vcc, 5, v2
s_and_saveexec_b64 s[40:41], vcc
ds_write_b128 v6, v[8:11] offset:34048
s_mov_b64 exec, s[40:41]
ds_write_b128 v6, v[16:19] offset:0
v_alignbit_b32 v72, v17, v16, 16
v_alignbit_b32 v73, v18, v17, 16
v_alignbit_b32 v74, v19, v18, 16
v_alignbit_b32 v75, v20, v19, 16
ds_write_b128 v6, v[72:75] offset:4256
s_nop 1
v_mov_b32 v72, v17
v_mov_b32 v73, v18
v_mov_b32 v74, v19
v_mov_b32 v75, v20
ds_write_b128 v6, v[72:75] offset:8512
s_nop 1
v_alignbit_b32 v72, v18, v17, 16
v_alignbit_b32 v73, v19, v18, 16
v_alignbit_b32 v74, v20, v19, 16
v_alignbit_b32 v75, v21, v20, 16
ds_write_b128 v6, v[72:75] offset:12768
s_nop 1
ds_write_b128 v6, v[18:21] offset:17024
v_alignbit_b32 v72, v19, v18, 16
v_alignbit_b32 v73, v20, v19, 16
v_alignbit_b32 v74, v21, v20, 16
v_alignbit_b32 v75, v22, v21, 16
ds_write_b128 v6, v[72:75] offset:21280
s_nop 1
v_mov_b32 v72, v19
v_mov_b32 v73, v20
v_mov_b32 v74, v21
v_mov_b32 v75, v22
ds_write_b128 v6, v[72:75] offset:25536
s_nop 1
v_alignbit_b32 v72, v20, v19, 16
v_alignbit_b32 v73, v21, v20, 16
v_alignbit_b32 v74, v22, v21, 16
v_alignbit_b32 v75, v23, v22, 16
ds_write_b128 v6, v[72:75] offset:29792
s_nop 1
ds_write_b128 v6, v[24:27] offset:1024
v_alignbit_b32 v72, v25, v24, 16
v_alignbit_b32 v73, v26, v25, 16
v_alignbit_b32 v74, v27, v26, 16
v_alignbit_b32 v75, v28, v27, 16
ds_write_b128 v6, v[72:75] offset:5280
s_nop 1
v_mov_b32 v72, v25
v_mov_b32 v73, v26
v_mov_b32 v74, v27
v_mov_b32 v75, v28
ds_write_b128 v6, v[72:75] offset:9536
s_nop 1
v_alignbit_b32 v72, v26, v25, 16
v_alignbit_b32 v73, v27, v26, 16
v_alignbit_b32 v74, v28, v27, 16
v_alignbit_b32 v75, v29, v28, 16
ds_write_b128 v6, v[72:75] offset:13792
s_nop 1
ds_write_b128 v6, v[26:29] offset:18048
v_alignbit_b32 v72, v27, v26, 16
v_alignbit_b32 v73, v28, v27, 16
v_alignbit_b32 v74, v29, v28, 16
v_alignbit_b32 v75, v30, v29, 16
ds_write_b128 v6, v[72:75] offset:22304
s_nop 1
v_mov_b32 v72, v27
v_mov_b32 v73, v28
v_mov_b32 v74, v29
v_mov_b32 v75, v30
ds_write_b128 v6, v[72:75] offset:26560
s_nop 1
v_alignbit_b32 v72, v28, v27, 16
v_alignbit_b32 v73, v29, v28, 16
v_alignbit_b32 v74, v30, v29, 16
v_alignbit_b32 v75, v31, v30, 16
ds_write_b128 v6, v[72:75] offset:30816
s_nop 1
ds_write_b128 v6, v[32:35] offset:2048
v_alignbit_b32 v72, v33, v32, 16
v_alignbit_b32 v73, v34, v33, 16
v_alignbit_b32 v74, v35, v34, 16
v_alignbit_b32 v75, v36, v35, 16
ds_write_b128 v6, v[72:75] offset:6304
s_nop 1
v_mov_b32 v72, v33
v_mov_b32 v73, v34
v_mov_b32 v74, v35
v_mov_b32 v75, v36
ds_write_b128 v6, v[72:75] offset:10560
s_nop 1
v_alignbit_b32 v72, v34, v33, 16
v_alignbit_b32 v73, v35, v34, 16
v_alignbit_b32 v74, v36, v35, 16
v_alignbit_b32 v75, v37, v36, 16
ds_write_b128 v6, v[72:75] offset:14816
s_nop 1
ds_write_b128 v6, v[34:37] offset:19072
v_alignbit_b32 v72, v35, v34, 16
v_alignbit_b32 v73, v36, v35, 16
v_alignbit_b32 v74, v37, v36, 16
v_alignbit_b32 v75, v38, v37, 16
ds_write_b128 v6, v[72:75] offset:23328
s_nop 1
v_mov_b32 v72, v35
v_mov_b32 v73, v36
v_mov_b32 v74, v37
v_mov_b32 v75, v38
ds_write_b128 v6, v[72:75] offset:27584
s_nop 1
v_alignbit_b32 v72, v36, v35, 16
v_alignbit_b32 v73, v37, v36, 16
v_alignbit_b32 v74, v38, v37, 16
v_alignbit_b32 v75, v39, v38, 16
ds_write_b128 v6, v[72:75] offset:31840
s_nop 1
ds_write_b128 v6, v[40:43] offset:3072
v_alignbit_b32 v72, v41, v40, 16
v_alignbit_b32 v73, v42, v41, 16
v_alignbit_b32 v74, v43, v42, 16
v_alignbit_b32 v75, v44, v43, 16
ds_write_b128 v6, v[72:75] offset:7328
s_nop 1
v_mov_b32 v72, v41
v_mov_b32 v73, v42
v_mov_b32 v74, v43
v_mov_b32 v75, v44
ds_write_b128 v6, v[72:75] offset:11584
s_nop 1
v_alignbit_b32 v72, v42, v41, 16
v_alignbit_b32 v73, v43, v42, 16
v_alignbit_b32 v74, v44, v43, 16
v_alignbit_b32 v75, v45, v44, 16
ds_write_b128 v6, v[72:75] offset:15840
s_nop 1
ds_write_b128 v6, v[42:45] offset:20096
v_alignbit_b32 v72, v43, v42, 16
v_alignbit_b32 v73, v44, v43, 16
v_alignbit_b32 v74, v45, v44, 16
v_alignbit_b32 v75, v46, v45, 16
ds_write_b128 v6, v[72:75] offset:24352
s_nop 1
v_mov_b32 v72, v43
v_mov_b32 v73, v44
v_mov_b32 v74, v45
v_mov_b32 v75, v46
ds_write_b128 v6, v[72:75] offset:28608
s_nop 1
v_alignbit_b32 v72, v44, v43, 16
v_alignbit_b32 v73, v45, v44, 16
v_alignbit_b32 v74, v46, v45, 16
v_alignbit_b32 v75, v47, v46, 16
ds_write_b128 v6, v[72:75] offset:32864
s_nop 1
v_cmp_gt_u32 vcc, 4, v2
s_and_saveexec_b64 s[40:41], vcc
ds_write_b128 v6, v[48:51] offset:4096
v_alignbit_b32 v72, v49, v48, 16
v_alignbit_b32 v73, v50, v49, 16
v_alignbit_b32 v74, v51, v50, 16
v_alignbit_b32 v75, v52, v51, 16
ds_write_b128 v6, v[72:75] offset:8352
s_nop 1
v_mov_b32 v72, v49
v_mov_b32 v73, v50
v_mov_b32 v74, v51
v_mov_b32 v75, v52
ds_write_b128 v6, v[72:75] offset:12608
s_nop 1
v_alignbit_b32 v72, v50, v49, 16
v_alignbit_b32 v73, v51, v50, 16
v_alignbit_b32 v74, v52, v51, 16
v_alignbit_b32 v75, v53, v52, 16
ds_write_b128 v6, v[72:75] offset:16864
s_nop 1
ds_write_b128 v6, v[50:53] offset:21120
v_alignbit_b32 v72, v51, v50, 16
v_alignbit_b32 v73, v52, v51, 16
v_alignbit_b32 v74, v53, v52, 16
v_alignbit_b32 v75, v54, v53, 16
ds_write_b128 v6, v[72:75] offset:25376
s_nop 1
v_mov_b32 v72, v51
v_mov_b32 v73, v52
v_mov_b32 v74, v53
v_mov_b32 v75, v54
ds_write_b128 v6, v[72:75] offset:29632
s_nop 1
v_alignbit_b32 v72, v52, v51, 16
v_alignbit_b32 v73, v53, v52, 16
v_alignbit_b32 v74, v54, v53, 16
v_alignbit_b32 v75, v55, v54, 16
ds_write_b128 v6, v[72:75] offset:33888
s_nop 1
s_mov_b64 exec, s[40:41]
v_and_b32 v7, 31, v2
v_add_u32 v7, 1, v7
v_lshrrev_b32 v12, 5, v2
v_and_b32 v13, 7, v7
v_mul_u32_u24 v13, 4256, v13
v_lshrrev_b32 v7, 3, v7
v_sub_u32 v7, v7, v12
v_add_u32 v7, 1, v7
v_lshlrev_b32 v7, 4, v7
v_add_u32 v7, v7, v13
v_add_u32 v7, s36, v7
v_and_b32 v13, 31, v2
v_mul_u32_u24 v13, 80, v13
v_add_u32 v13, 80, v13
v_lshlrev_b32 v12, 4, v12
v_add_u32 v12, 34048, v12
v_add_u32 v12, s36, v12
v_add_u32 v14, v13, v12
v_mov_b32 v96, 0
v_mov_b32 v97, 0
v_mov_b32 v98, 0
v_mov_b32 v99, 0
v_mov_b32 v100, 0
v_mov_b32 v101, 0
v_mov_b32 v102, 0
v_mov_b32 v103, 0
v_mov_b32 v104, 0
v_mov_b32 v105, 0
v_mov_b32 v106, 0
v_mov_b32 v107, 0
v_mov_b32 v108, 0
v_mov_b32 v109, 0
v_mov_b32 v110, 0
v_mov_b32 v111, 0
v_mov_b32 v112, 0
v_mov_b32 v113, 0
v_mov_b32 v114, 0
v_mov_b32 v115, 0
v_mov_b32 v116, 0
v_mov_b32 v117, 0
v_mov_b32 v118, 0
v_mov_b32 v119, 0
v_mov_b32 v120, 0
v_mov_b32 v121, 0
v_mov_b32 v122, 0
v_mov_b32 v123, 0
v_mov_b32 v124, 0
v_mov_b32 v125, 0
v_mov_b32 v126, 0
v_mov_b32 v127, 0
s_waitcnt lgkmcnt(0)
ds_read_b128 v[128:131], v7 offset:32
ds_read_b128 v[132:135], v7 offset:0
ds_read_b128 v[136:139], v14 offset:2560
ds_read_b128 v[140:143], v14 offset:2592
v_add_u32 v15, 0, v13
v_max_i32 v15, 0, v15
v_add_u32 v15, v15, v12
ds_read_b128 v[144:147], v15
ds_read_b128 v[148:151], v15 offset:32
ds_read_b128 v[152:155], v7 offset:96
ds_read_b128 v[156:159], v7 offset:64
ds_read_b128 v[160:163], v14 offset:2480
ds_read_b128 v[164:167], v14 offset:2512
v_add_u32 v15, 4294967216, v13
v_max_i32 v15, 0, v15
v_add_u32 v15, v15, v12
ds_read_b128 v[168:171], v15
ds_read_b128 v[172:175], v15 offset:32
s_waitcnt lgkmcnt(6)
v_mfma_f32_32x32x16_bf16 v[112:127], v[128:131], v[136:139], v[112:127]
v_mfma_f32_32x32x16_bf16 v[112:127], v[132:135], v[140:143], v[112:127]
v_mfma_f32_32x32x16_bf16 v[96:111], v[128:131], v[144:147], v[96:111]
v_mfma_f32_32x32x16_bf16 v[96:111], v[132:135], v[148:151], v[96:111]
ds_read_b128 v[128:131], v7 offset:160
ds_read_b128 v[132:135], v7 offset:128
ds_read_b128 v[136:139], v14 offset:2400
ds_read_b128 v[140:143], v14 offset:2432
v_add_u32 v15, 4294967136, v13
v_max_i32 v15, 0, v15
v_add_u32 v15, v15, v12
ds_read_b128 v[144:147], v15
ds_read_b128 v[148:151], v15 offset:32
s_waitcnt lgkmcnt(6)
v_mfma_f32_32x32x16_bf16 v[112:127], v[152:155], v[160:163], v[112:127]
v_mfma_f32_32x32x16_bf16 v[112:127], v[156:159], v[164:167], v[112:127]
v_mfma_f32_32x32x16_bf16 v[96:111], v[152:155], v[168:171], v[96:111]
v_mfma_f32_32x32x16_bf16 v[96:111], v[156:159], v[172:175], v[96:111]
ds_read_b128 v[152:155], v7 offset:224
ds_read_b128 v[156:159], v7 offset:192
ds_read_b128 v[160:163], v14 offset:2320
ds_read_b128 v[164:167], v14 offset:2352
v_add_u32 v15, 4294967056, v13
v_max_i32 v15, 0, v15
v_add_u32 v15, v15, v12
ds_read_b128 v[168:171], v15
ds_read_b128 v[172:175], v15 offset:32
s_waitcnt lgkmcnt(6)
v_mfma_f32_32x32x16_bf16 v[112:127], v[128:131], v[136:139], v[112:127]
v_mfma_f32_32x32x16_bf16 v[112:127], v[132:135], v[140:143], v[112:127]
v_mfma_f32_32x32x16_bf16 v[96:111], v[128:131], v[144:147], v[96:111]
v_mfma_f32_32x32x16_bf16 v[96:111], v[132:135], v[148:151], v[96:111]
ds_read_b128 v[128:131], v7 offset:288
ds_read_b128 v[132:135], v7 offset:256
ds_read_b128 v[136:139], v14 offset:2240
ds_read_b128 v[140:143], v14 offset:2272
v_add_u32 v15, 4294966976, v13
v_max_i32 v15, 0, v15
v_add_u32 v15, v15, v12
ds_read_b128 v[144:147], v15
ds_read_b128 v[148:151], v15 offset:32
s_waitcnt lgkmcnt(6)
v_mfma_f32_32x32x16_bf16 v[112:127], v[152:155], v[160:163], v[112:127]
v_mfma_f32_32x32x16_bf16 v[112:127], v[156:159], v[164:167], v[112:127]
v_mfma_f32_32x32x16_bf16 v[96:111], v[152:155], v[168:171], v[96:111]
v_mfma_f32_32x32x16_bf16 v[96:111], v[156:159], v[172:175], v[96:111]
ds_read_b128 v[152:155], v7 offset:352
ds_read_b128 v[156:159], v7 offset:320
ds_read_b128 v[160:163], v14 offset:2160
ds_read_b128 v[164:167], v14 offset:2192
v_add_u32 v15, 4294966896, v13
v_max_i32 v15, 0, v15
v_add_u32 v15, v15, v12
ds_read_b128 v[168:171], v15
ds_read_b128 v[172:175], v15 offset:32
s_waitcnt lgkmcnt(6)
v_mfma_f32_32x32x16_bf16 v[112:127], v[128:131], v[136:139], v[112:127]
v_mfma_f32_32x32x16_bf16 v[112:127], v[132:135], v[140:143], v[112:127]
v_mfma_f32_32x32x16_bf16 v[96:111], v[128:131], v[144:147], v[96:111]
v_mfma_f32_32x32x16_bf16 v[96:111], v[132:135], v[148:151], v[96:111]
ds_read_b128 v[128:131], v7 offset:416
ds_read_b128 v[132:135], v7 offset:384
ds_read_b128 v[136:139], v14 offset:2080
ds_read_b128 v[140:143], v14 offset:2112
v_add_u32 v15, 4294966816, v13
v_max_i32 v15, 0, v15
v_add_u32 v15, v15, v12
ds_read_b128 v[144:147], v15
ds_read_b128 v[148:151], v15 offset:32
s_waitcnt lgkmcnt(6)
v_mfma_f32_32x32x16_bf16 v[112:127], v[152:155], v[160:163], v[112:127]
v_mfma_f32_32x32x16_bf16 v[112:127], v[156:159], v[164:167], v[112:127]
v_mfma_f32_32x32x16_bf16 v[96:111], v[152:155], v[168:171], v[96:111]
v_mfma_f32_32x32x16_bf16 v[96:111], v[156:159], v[172:175], v[96:111]
ds_read_b128 v[152:155], v7 offset:480
ds_read_b128 v[156:159], v7 offset:448
ds_read_b128 v[160:163], v14 offset:2000
ds_read_b128 v[164:167], v14 offset:2032
v_add_u32 v15, 4294966736, v13
v_max_i32 v15, 0, v15
v_add_u32 v15, v15, v12
ds_read_b128 v[168:171], v15
ds_read_b128 v[172:175], v15 offset:32
s_waitcnt lgkmcnt(6)
v_mfma_f32_32x32x16_bf16 v[112:127], v[128:131], v[136:139], v[112:127]
v_mfma_f32_32x32x16_bf16 v[112:127], v[132:135], v[140:143], v[112:127]
v_mfma_f32_32x32x16_bf16 v[96:111], v[128:131], v[144:147], v[96:111]
v_mfma_f32_32x32x16_bf16 v[96:111], v[132:135], v[148:151], v[96:111]
ds_read_b128 v[128:131], v7 offset:544
ds_read_b128 v[132:135], v7 offset:512
ds_read_b128 v[136:139], v14 offset:1920
ds_read_b128 v[140:143], v14 offset:1952
v_add_u32 v15, 4294966656, v13
v_max_i32 v15, 0, v15
v_add_u32 v15, v15, v12
ds_read_b128 v[144:147], v15
ds_read_b128 v[148:151], v15 offset:32
s_waitcnt lgkmcnt(6)
v_mfma_f32_32x32x16_bf16 v[112:127], v[152:155], v[160:163], v[112:127]
v_mfma_f32_32x32x16_bf16 v[112:127], v[156:159], v[164:167], v[112:127]
v_mfma_f32_32x32x16_bf16 v[96:111], v[152:155], v[168:171], v[96:111]
v_mfma_f32_32x32x16_bf16 v[96:111], v[156:159], v[172:175], v[96:111]
ds_read_b128 v[152:155], v7 offset:608
ds_read_b128 v[156:159], v7 offset:576
ds_read_b128 v[160:163], v14 offset:1840
ds_read_b128 v[164:167], v14 offset:1872
v_add_u32 v15, 4294966576, v13
v_max_i32 v15, 0, v15
v_add_u32 v15, v15, v12
ds_read_b128 v[168:171], v15
ds_read_b128 v[172:175], v15 offset:32
s_waitcnt lgkmcnt(6)
v_mfma_f32_32x32x16_bf16 v[112:127], v[128:131], v[136:139], v[112:127]
v_mfma_f32_32x32x16_bf16 v[112:127], v[132:135], v[140:143], v[112:127]
v_mfma_f32_32x32x16_bf16 v[96:111], v[128:131], v[144:147], v[96:111]
v_mfma_f32_32x32x16_bf16 v[96:111], v[132:135], v[148:151], v[96:111]
ds_read_b128 v[128:131], v7 offset:672
ds_read_b128 v[132:135], v7 offset:640
ds_read_b128 v[136:139], v14 offset:1760
ds_read_b128 v[140:143], v14 offset:1792
v_add_u32 v15, 4294966496, v13
v_max_i32 v15, 0, v15
v_add_u32 v15, v15, v12
ds_read_b128 v[144:147], v15
ds_read_b128 v[148:151], v15 offset:32
s_waitcnt lgkmcnt(6)
v_mfma_f32_32x32x16_bf16 v[112:127], v[152:155], v[160:163], v[112:127]
v_mfma_f32_32x32x16_bf16 v[112:127], v[156:159], v[164:167], v[112:127]
v_mfma_f32_32x32x16_bf16 v[96:111], v[152:155], v[168:171], v[96:111]
v_mfma_f32_32x32x16_bf16 v[96:111], v[156:159], v[172:175], v[96:111]
ds_read_b128 v[152:155], v7 offset:736
ds_read_b128 v[156:159], v7 offset:704
ds_read_b128 v[160:163], v14 offset:1680
ds_read_b128 v[164:167], v14 offset:1712
v_add_u32 v15, 4294966416, v13
v_max_i32 v15, 0, v15
v_add_u32 v15, v15, v12
ds_read_b128 v[168:171], v15
ds_read_b128 v[172:175], v15 offset:32
s_waitcnt lgkmcnt(6)
v_mfma_f32_32x32x16_bf16 v[112:127], v[128:131], v[136:139], v[112:127]
v_mfma_f32_32x32x16_bf16 v[112:127], v[132:135], v[140:143], v[112:127]
v_mfma_f32_32x32x16_bf16 v[96:111], v[128:131], v[144:147], v[96:111]
v_mfma_f32_32x32x16_bf16 v[96:111], v[132:135], v[148:151], v[96:111]
ds_read_b128 v[128:131], v7 offset:800
ds_read_b128 v[132:135], v7 offset:768
ds_read_b128 v[136:139], v14 offset:1600
ds_read_b128 v[140:143], v14 offset:1632
v_add_u32 v15, 4294966336, v13
v_max_i32 v15, 0, v15
v_add_u32 v15, v15, v12
ds_read_b128 v[144:147], v15
ds_read_b128 v[148:151], v15 offset:32
s_waitcnt lgkmcnt(6)
v_mfma_f32_32x32x16_bf16 v[112:127], v[152:155], v[160:163], v[112:127]
v_mfma_f32_32x32x16_bf16 v[112:127], v[156:159], v[164:167], v[112:127]
v_mfma_f32_32x32x16_bf16 v[96:111], v[152:155], v[168:171], v[96:111]
v_mfma_f32_32x32x16_bf16 v[96:111], v[156:159], v[172:175], v[96:111]
ds_read_b128 v[152:155], v7 offset:864
ds_read_b128 v[156:159], v7 offset:832
ds_read_b128 v[160:163], v14 offset:1520
ds_read_b128 v[164:167], v14 offset:1552
v_add_u32 v15, 4294966256, v13
v_max_i32 v15, 0, v15
v_add_u32 v15, v15, v12
ds_read_b128 v[168:171], v15
ds_read_b128 v[172:175], v15 offset:32
s_waitcnt lgkmcnt(6)
v_mfma_f32_32x32x16_bf16 v[112:127], v[128:131], v[136:139], v[112:127]
v_mfma_f32_32x32x16_bf16 v[112:127], v[132:135], v[140:143], v[112:127]
v_mfma_f32_32x32x16_bf16 v[96:111], v[128:131], v[144:147], v[96:111]
v_mfma_f32_32x32x16_bf16 v[96:111], v[132:135], v[148:151], v[96:111]
ds_read_b128 v[128:131], v7 offset:928
ds_read_b128 v[132:135], v7 offset:896
ds_read_b128 v[136:139], v14 offset:1440
ds_read_b128 v[140:143], v14 offset:1472
v_add_u32 v15, 4294966176, v13
v_max_i32 v15, 0, v15
v_add_u32 v15, v15, v12
ds_read_b128 v[144:147], v15
ds_read_b128 v[148:151], v15 offset:32
s_waitcnt lgkmcnt(6)
v_mfma_f32_32x32x16_bf16 v[112:127], v[152:155], v[160:163], v[112:127]
v_mfma_f32_32x32x16_bf16 v[112:127], v[156:159], v[164:167], v[112:127]
v_mfma_f32_32x32x16_bf16 v[96:111], v[152:155], v[168:171], v[96:111]
v_mfma_f32_32x32x16_bf16 v[96:111], v[156:159], v[172:175], v[96:111]
ds_read_b128 v[152:155], v7 offset:992
ds_read_b128 v[156:159], v7 offset:960
ds_read_b128 v[160:163], v14 offset:1360
ds_read_b128 v[164:167], v14 offset:1392
v_add_u32 v15, 4294966096, v13
v_max_i32 v15, 0, v15
v_add_u32 v15, v15, v12
ds_read_b128 v[168:171], v15
ds_read_b128 v[172:175], v15 offset:32
s_waitcnt lgkmcnt(6)
v_mfma_f32_32x32x16_bf16 v[112:127], v[128:131], v[136:139], v[112:127]
v_mfma_f32_32x32x16_bf16 v[112:127], v[132:135], v[140:143], v[112:127]
v_mfma_f32_32x32x16_bf16 v[96:111], v[128:131], v[144:147], v[96:111]
v_mfma_f32_32x32x16_bf16 v[96:111], v[132:135], v[148:151], v[96:111]
ds_read_b128 v[128:131], v7 offset:1056
ds_read_b128 v[132:135], v7 offset:1024
ds_read_b128 v[136:139], v14 offset:1280
ds_read_b128 v[140:143], v14 offset:1312
v_add_u32 v15, 4294966016, v13
v_max_i32 v15, 0, v15
v_add_u32 v15, v15, v12
ds_read_b128 v[144:147], v15
ds_read_b128 v[148:151], v15 offset:32
s_waitcnt lgkmcnt(6)
v_mfma_f32_32x32x16_bf16 v[112:127], v[152:155], v[160:163], v[112:127]
v_mfma_f32_32x32x16_bf16 v[112:127], v[156:159], v[164:167], v[112:127]
v_mfma_f32_32x32x16_bf16 v[96:111], v[152:155], v[168:171], v[96:111]
v_mfma_f32_32x32x16_bf16 v[96:111], v[156:159], v[172:175], v[96:111]
ds_read_b128 v[152:155], v7 offset:1120
ds_read_b128 v[156:159], v7 offset:1088
ds_read_b128 v[160:163], v14 offset:1200
ds_read_b128 v[164:167], v14 offset:1232
v_add_u32 v15, 4294965936, v13
v_max_i32 v15, 0, v15
v_add_u32 v15, v15, v12
ds_read_b128 v[168:171], v15
ds_read_b128 v[172:175], v15 offset:32
s_waitcnt lgkmcnt(6)
v_mfma_f32_32x32x16_bf16 v[112:127], v[128:131], v[136:139], v[112:127]
v_mfma_f32_32x32x16_bf16 v[112:127], v[132:135], v[140:143], v[112:127]
v_mfma_f32_32x32x16_bf16 v[96:111], v[128:131], v[144:147], v[96:111]
v_mfma_f32_32x32x16_bf16 v[96:111], v[132:135], v[148:151], v[96:111]
ds_read_b128 v[128:131], v7 offset:1184
ds_read_b128 v[132:135], v7 offset:1152
ds_read_b128 v[136:139], v14 offset:1120
ds_read_b128 v[140:143], v14 offset:1152
v_add_u32 v15, 4294965856, v13
v_max_i32 v15, 0, v15
v_add_u32 v15, v15, v12
ds_read_b128 v[144:147], v15
ds_read_b128 v[148:151], v15 offset:32
s_waitcnt lgkmcnt(6)
v_mfma_f32_32x32x16_bf16 v[112:127], v[152:155], v[160:163], v[112:127]
v_mfma_f32_32x32x16_bf16 v[112:127], v[156:159], v[164:167], v[112:127]
v_mfma_f32_32x32x16_bf16 v[96:111], v[152:155], v[168:171], v[96:111]
v_mfma_f32_32x32x16_bf16 v[96:111], v[156:159], v[172:175], v[96:111]
ds_read_b128 v[152:155], v7 offset:1248
ds_read_b128 v[156:159], v7 offset:1216
ds_read_b128 v[160:163], v14 offset:1040
ds_read_b128 v[164:167], v14 offset:1072
v_add_u32 v15, 4294965776, v13
v_max_i32 v15, 0, v15
v_add_u32 v15, v15, v12
ds_read_b128 v[168:171], v15
ds_read_b128 v[172:175], v15 offset:32
s_waitcnt lgkmcnt(6)
v_mfma_f32_32x32x16_bf16 v[112:127], v[128:131], v[136:139], v[112:127]
v_mfma_f32_32x32x16_bf16 v[112:127], v[132:135], v[140:143], v[112:127]
v_mfma_f32_32x32x16_bf16 v[96:111], v[128:131], v[144:147], v[96:111]
v_mfma_f32_32x32x16_bf16 v[96:111], v[132:135], v[148:151], v[96:111]
ds_read_b128 v[128:131], v7 offset:1312
ds_read_b128 v[132:135], v7 offset:1280
ds_read_b128 v[136:139], v14 offset:960
ds_read_b128 v[140:143], v14 offset:992
v_add_u32 v15, 4294965696, v13
v_max_i32 v15, 0, v15
v_add_u32 v15, v15, v12
ds_read_b128 v[144:147], v15
ds_read_b128 v[148:151], v15 offset:32
s_waitcnt lgkmcnt(6)
v_mfma_f32_32x32x16_bf16 v[112:127], v[152:155], v[160:163], v[112:127]
v_mfma_f32_32x32x16_bf16 v[112:127], v[156:159], v[164:167], v[112:127]
v_mfma_f32_32x32x16_bf16 v[96:111], v[152:155], v[168:171], v[96:111]
v_mfma_f32_32x32x16_bf16 v[96:111], v[156:159], v[172:175], v[96:111]
ds_read_b128 v[152:155], v7 offset:1376
ds_read_b128 v[156:159], v7 offset:1344
ds_read_b128 v[160:163], v14 offset:880
ds_read_b128 v[164:167], v14 offset:912
v_add_u32 v15, 4294965616, v13
v_max_i32 v15, 0, v15
v_add_u32 v15, v15, v12
ds_read_b128 v[168:171], v15
ds_read_b128 v[172:175], v15 offset:32
s_waitcnt lgkmcnt(6)
v_mfma_f32_32x32x16_bf16 v[112:127], v[128:131], v[136:139], v[112:127]
v_mfma_f32_32x32x16_bf16 v[112:127], v[132:135], v[140:143], v[112:127]
v_mfma_f32_32x32x16_bf16 v[96:111], v[128:131], v[144:147], v[96:111]
v_mfma_f32_32x32x16_bf16 v[96:111], v[132:135], v[148:151], v[96:111]
ds_read_b128 v[128:131], v7 offset:1440
ds_read_b128 v[132:135], v7 offset:1408
ds_read_b128 v[136:139], v14 offset:800
ds_read_b128 v[140:143], v14 offset:832
v_add_u32 v15, 4294965536, v13
v_max_i32 v15, 0, v15
v_add_u32 v15, v15, v12
ds_read_b128 v[144:147], v15
ds_read_b128 v[148:151], v15 offset:32
s_waitcnt lgkmcnt(6)
v_mfma_f32_32x32x16_bf16 v[112:127], v[152:155], v[160:163], v[112:127]
v_mfma_f32_32x32x16_bf16 v[112:127], v[156:159], v[164:167], v[112:127]
v_mfma_f32_32x32x16_bf16 v[96:111], v[152:155], v[168:171], v[96:111]
v_mfma_f32_32x32x16_bf16 v[96:111], v[156:159], v[172:175], v[96:111]
ds_read_b128 v[152:155], v7 offset:1504
ds_read_b128 v[156:159], v7 offset:1472
ds_read_b128 v[160:163], v14 offset:720
ds_read_b128 v[164:167], v14 offset:752
v_add_u32 v15, 4294965456, v13
v_max_i32 v15, 0, v15
v_add_u32 v15, v15, v12
ds_read_b128 v[168:171], v15
ds_read_b128 v[172:175], v15 offset:32
s_waitcnt lgkmcnt(6)
v_mfma_f32_32x32x16_bf16 v[112:127], v[128:131], v[136:139], v[112:127]
v_mfma_f32_32x32x16_bf16 v[112:127], v[132:135], v[140:143], v[112:127]
v_mfma_f32_32x32x16_bf16 v[96:111], v[128:131], v[144:147], v[96:111]
v_mfma_f32_32x32x16_bf16 v[96:111], v[132:135], v[148:151], v[96:111]
ds_read_b128 v[128:131], v7 offset:1568
ds_read_b128 v[132:135], v7 offset:1536
ds_read_b128 v[136:139], v14 offset:640
ds_read_b128 v[140:143], v14 offset:672
v_add_u32 v15, 4294965376, v13
v_max_i32 v15, 0, v15
v_add_u32 v15, v15, v12
ds_read_b128 v[144:147], v15
ds_read_b128 v[148:151], v15 offset:32
s_waitcnt lgkmcnt(6)
v_mfma_f32_32x32x16_bf16 v[112:127], v[152:155], v[160:163], v[112:127]
v_mfma_f32_32x32x16_bf16 v[112:127], v[156:159], v[164:167], v[112:127]
v_mfma_f32_32x32x16_bf16 v[96:111], v[152:155], v[168:171], v[96:111]
v_mfma_f32_32x32x16_bf16 v[96:111], v[156:159], v[172:175], v[96:111]
ds_read_b128 v[152:155], v7 offset:1632
ds_read_b128 v[156:159], v7 offset:1600
ds_read_b128 v[160:163], v14 offset:560
ds_read_b128 v[164:167], v14 offset:592
v_add_u32 v15, 4294965296, v13
v_max_i32 v15, 0, v15
v_add_u32 v15, v15, v12
ds_read_b128 v[168:171], v15
ds_read_b128 v[172:175], v15 offset:32
s_waitcnt lgkmcnt(6)
v_mfma_f32_32x32x16_bf16 v[112:127], v[128:131], v[136:139], v[112:127]
v_mfma_f32_32x32x16_bf16 v[112:127], v[132:135], v[140:143], v[112:127]
v_mfma_f32_32x32x16_bf16 v[96:111], v[128:131], v[144:147], v[96:111]
v_mfma_f32_32x32x16_bf16 v[96:111], v[132:135], v[148:151], v[96:111]
ds_read_b128 v[128:131], v7 offset:1696
ds_read_b128 v[132:135], v7 offset:1664
ds_read_b128 v[136:139], v14 offset:480
ds_read_b128 v[140:143], v14 offset:512
v_add_u32 v15, 4294965216, v13
v_max_i32 v15, 0, v15
v_add_u32 v15, v15, v12
ds_read_b128 v[144:147], v15
ds_read_b128 v[148:151], v15 offset:32
s_waitcnt lgkmcnt(6)
v_mfma_f32_32x32x16_bf16 v[112:127], v[152:155], v[160:163], v[112:127]
v_mfma_f32_32x32x16_bf16 v[112:127], v[156:159], v[164:167], v[112:127]
v_mfma_f32_32x32x16_bf16 v[96:111], v[152:155], v[168:171], v[96:111]
v_mfma_f32_32x32x16_bf16 v[96:111], v[156:159], v[172:175], v[96:111]
ds_read_b128 v[152:155], v7 offset:1760
ds_read_b128 v[156:159], v7 offset:1728
ds_read_b128 v[160:163], v14 offset:400
ds_read_b128 v[164:167], v14 offset:432
v_add_u32 v15, 4294965136, v13
v_max_i32 v15, 0, v15
v_add_u32 v15, v15, v12
ds_read_b128 v[168:171], v15
ds_read_b128 v[172:175], v15 offset:32
s_waitcnt lgkmcnt(6)
v_mfma_f32_32x32x16_bf16 v[112:127], v[128:131], v[136:139], v[112:127]
v_mfma_f32_32x32x16_bf16 v[112:127], v[132:135], v[140:143], v[112:127]
v_mfma_f32_32x32x16_bf16 v[96:111], v[128:131], v[144:147], v[96:111]
v_mfma_f32_32x32x16_bf16 v[96:111], v[132:135], v[148:151], v[96:111]
ds_read_b128 v[128:131], v7 offset:1824
ds_read_b128 v[132:135], v7 offset:1792
ds_read_b128 v[136:139], v14 offset:320
ds_read_b128 v[140:143], v14 offset:352
v_add_u32 v15, 4294965056, v13
v_max_i32 v15, 0, v15
v_add_u32 v15, v15, v12
ds_read_b128 v[144:147], v15
ds_read_b128 v[148:151], v15 offset:32
s_waitcnt lgkmcnt(6)
v_mfma_f32_32x32x16_bf16 v[112:127], v[152:155], v[160:163], v[112:127]
v_mfma_f32_32x32x16_bf16 v[112:127], v[156:159], v[164:167], v[112:127]
v_mfma_f32_32x32x16_bf16 v[96:111], v[152:155], v[168:171], v[96:111]
v_mfma_f32_32x32x16_bf16 v[96:111], v[156:159], v[172:175], v[96:111]
ds_read_b128 v[152:155], v7 offset:1888
ds_read_b128 v[156:159], v7 offset:1856
ds_read_b128 v[160:163], v14 offset:240
ds_read_b128 v[164:167], v14 offset:272
v_add_u32 v15, 4294964976, v13
v_max_i32 v15, 0, v15
v_add_u32 v15, v15, v12
ds_read_b128 v[168:171], v15
ds_read_b128 v[172:175], v15 offset:32
s_waitcnt lgkmcnt(6)
v_mfma_f32_32x32x16_bf16 v[112:127], v[128:131], v[136:139], v[112:127]
v_mfma_f32_32x32x16_bf16 v[112:127], v[132:135], v[140:143], v[112:127]
v_mfma_f32_32x32x16_bf16 v[96:111], v[128:131], v[144:147], v[96:111]
v_mfma_f32_32x32x16_bf16 v[96:111], v[132:135], v[148:151], v[96:111]
ds_read_b128 v[128:131], v7 offset:1952
ds_read_b128 v[132:135], v7 offset:1920
ds_read_b128 v[136:139], v14 offset:160
ds_read_b128 v[140:143], v14 offset:192
v_add_u32 v15, 4294964896, v13
v_max_i32 v15, 0, v15
v_add_u32 v15, v15, v12
ds_read_b128 v[144:147], v15
ds_read_b128 v[148:151], v15 offset:32
s_waitcnt lgkmcnt(6)
v_mfma_f32_32x32x16_bf16 v[112:127], v[152:155], v[160:163], v[112:127]
v_mfma_f32_32x32x16_bf16 v[112:127], v[156:159], v[164:167], v[112:127]
v_mfma_f32_32x32x16_bf16 v[96:111], v[152:155], v[168:171], v[96:111]
v_mfma_f32_32x32x16_bf16 v[96:111], v[156:159], v[172:175], v[96:111]
ds_read_b128 v[152:155], v7 offset:2016
ds_read_b128 v[156:159], v7 offset:1984
ds_read_b128 v[160:163], v14 offset:80
ds_read_b128 v[164:167], v14 offset:112
v_add_u32 v15, 4294964816, v13
v_max_i32 v15, 0, v15
v_add_u32 v15, v15, v12
ds_read_b128 v[168:171], v15
ds_read_b128 v[172:175], v15 offset:32
s_waitcnt lgkmcnt(6)
v_mfma_f32_32x32x16_bf16 v[112:127], v[128:131], v[136:139], v[112:127]
v_mfma_f32_32x32x16_bf16 v[112:127], v[132:135], v[140:143], v[112:127]
v_mfma_f32_32x32x16_bf16 v[96:111], v[128:131], v[144:147], v[96:111]
v_mfma_f32_32x32x16_bf16 v[96:111], v[132:135], v[148:151], v[96:111]
ds_read_b128 v[128:131], v7 offset:2080
ds_read_b128 v[132:135], v7 offset:2048
ds_read_b128 v[136:139], v14 offset:0
ds_read_b128 v[140:143], v14 offset:32
s_waitcnt lgkmcnt(4)
v_mfma_f32_32x32x16_bf16 v[112:127], v[152:155], v[160:163], v[112:127]
v_mfma_f32_32x32x16_bf16 v[112:127], v[156:159], v[164:167], v[112:127]
v_mfma_f32_32x32x16_bf16 v[96:111], v[152:155], v[168:171], v[96:111]
v_mfma_f32_32x32x16_bf16 v[96:111], v[156:159], v[172:175], v[96:111]
ds_read_b128 v[152:155], v7 offset:2144
ds_read_b128 v[156:159], v7 offset:2112
v_add_u32 v15, 4294967216, v13
v_max_i32 v15, 0, v15
v_add_u32 v15, v15, v12
ds_read_b128 v[160:163], v15 offset:0
ds_read_b128 v[164:167], v15 offset:32
s_waitcnt lgkmcnt(4)
v_mfma_f32_32x32x16_bf16 v[112:127], v[128:131], v[136:139], v[112:127]
v_mfma_f32_32x32x16_bf16 v[112:127], v[132:135], v[140:143], v[112:127]
ds_read_b128 v[128:131], v7 offset:2208
ds_read_b128 v[132:135], v7 offset:2176
v_add_u32 v15, 4294967136, v13
v_max_i32 v15, 0, v15
v_add_u32 v15, v15, v12
ds_read_b128 v[136:139], v15 offset:0
ds_read_b128 v[140:143], v15 offset:32
s_waitcnt lgkmcnt(4)
v_mfma_f32_32x32x16_bf16 v[112:127], v[152:155], v[160:163], v[112:127]
v_mfma_f32_32x32x16_bf16 v[112:127], v[156:159], v[164:167], v[112:127]
ds_read_b128 v[152:155], v7 offset:2272
ds_read_b128 v[156:159], v7 offset:2240
v_add_u32 v15, 4294967056, v13
v_max_i32 v15, 0, v15
v_add_u32 v15, v15, v12
ds_read_b128 v[160:163], v15 offset:0
ds_read_b128 v[164:167], v15 offset:32
s_waitcnt lgkmcnt(4)
v_mfma_f32_32x32x16_bf16 v[112:127], v[128:131], v[136:139], v[112:127]
v_mfma_f32_32x32x16_bf16 v[112:127], v[132:135], v[140:143], v[112:127]
ds_read_b128 v[128:131], v7 offset:2336
ds_read_b128 v[132:135], v7 offset:2304
v_add_u32 v15, 4294966976, v13
v_max_i32 v15, 0, v15
v_add_u32 v15, v15, v12
ds_read_b128 v[136:139], v15 offset:0
ds_read_b128 v[140:143], v15 offset:32
s_waitcnt lgkmcnt(4)
v_mfma_f32_32x32x16_bf16 v[112:127], v[152:155], v[160:163], v[112:127]
v_mfma_f32_32x32x16_bf16 v[112:127], v[156:159], v[164:167], v[112:127]
ds_read_b128 v[152:155], v7 offset:2400
ds_read_b128 v[156:159], v7 offset:2368
v_add_u32 v15, 4294966896, v13
v_max_i32 v15, 0, v15
v_add_u32 v15, v15, v12
ds_read_b128 v[160:163], v15 offset:0
ds_read_b128 v[164:167], v15 offset:32
s_waitcnt lgkmcnt(4)
v_mfma_f32_32x32x16_bf16 v[112:127], v[128:131], v[136:139], v[112:127]
v_mfma_f32_32x32x16_bf16 v[112:127], v[132:135], v[140:143], v[112:127]
ds_read_b128 v[128:131], v7 offset:2464
ds_read_b128 v[132:135], v7 offset:2432
v_add_u32 v15, 4294966816, v13
v_max_i32 v15, 0, v15
v_add_u32 v15, v15, v12
ds_read_b128 v[136:139], v15 offset:0
ds_read_b128 v[140:143], v15 offset:32
s_waitcnt lgkmcnt(4)
v_mfma_f32_32x32x16_bf16 v[112:127], v[152:155], v[160:163], v[112:127]
v_mfma_f32_32x32x16_bf16 v[112:127], v[156:159], v[164:167], v[112:127]
ds_read_b128 v[152:155], v7 offset:2528
ds_read_b128 v[156:159], v7 offset:2496
v_add_u32 v15, 4294966736, v13
v_max_i32 v15, 0, v15
v_add_u32 v15, v15, v12
ds_read_b128 v[160:163], v15 offset:0
ds_read_b128 v[164:167], v15 offset:32
s_waitcnt lgkmcnt(4)
v_mfma_f32_32x32x16_bf16 v[112:127], v[128:131], v[136:139], v[112:127]
v_mfma_f32_32x32x16_bf16 v[112:127], v[132:135], v[140:143], v[112:127]
ds_read_b128 v[128:131], v7 offset:2592
ds_read_b128 v[132:135], v7 offset:2560
v_add_u32 v15, 4294966656, v13
v_max_i32 v15, 0, v15
v_add_u32 v15, v15, v12
ds_read_b128 v[136:139], v15 offset:0
ds_read_b128 v[140:143], v15 offset:32
s_waitcnt lgkmcnt(4)
v_mfma_f32_32x32x16_bf16 v[112:127], v[152:155], v[160:163], v[112:127]
v_mfma_f32_32x32x16_bf16 v[112:127], v[156:159], v[164:167], v[112:127]
ds_read_b128 v[152:155], v7 offset:2656
ds_read_b128 v[156:159], v7 offset:2624
v_add_u32 v15, 4294966576, v13
v_max_i32 v15, 0, v15
v_add_u32 v15, v15, v12
ds_read_b128 v[160:163], v15 offset:0
ds_read_b128 v[164:167], v15 offset:32
s_waitcnt lgkmcnt(4)
v_mfma_f32_32x32x16_bf16 v[112:127], v[128:131], v[136:139], v[112:127]
v_mfma_f32_32x32x16_bf16 v[112:127], v[132:135], v[140:143], v[112:127]
ds_read_b128 v[128:131], v7 offset:2720
ds_read_b128 v[132:135], v7 offset:2688
v_add_u32 v15, 4294966496, v13
v_max_i32 v15, 0, v15
v_add_u32 v15, v15, v12
ds_read_b128 v[136:139], v15 offset:0
ds_read_b128 v[140:143], v15 offset:32
s_waitcnt lgkmcnt(4)
v_mfma_f32_32x32x16_bf16 v[112:127], v[152:155], v[160:163], v[112:127]
v_mfma_f32_32x32x16_bf16 v[112:127], v[156:159], v[164:167], v[112:127]
ds_read_b128 v[152:155], v7 offset:2784
ds_read_b128 v[156:159], v7 offset:2752
v_add_u32 v15, 4294966416, v13
v_max_i32 v15, 0, v15
v_add_u32 v15, v15, v12
ds_read_b128 v[160:163], v15 offset:0
ds_read_b128 v[164:167], v15 offset:32
s_waitcnt lgkmcnt(4)
v_mfma_f32_32x32x16_bf16 v[112:127], v[128:131], v[136:139], v[112:127]
v_mfma_f32_32x32x16_bf16 v[112:127], v[132:135], v[140:143], v[112:127]
ds_read_b128 v[128:131], v7 offset:2848
ds_read_b128 v[132:135], v7 offset:2816
v_add_u32 v15, 4294966336, v13
v_max_i32 v15, 0, v15
v_add_u32 v15, v15, v12
ds_read_b128 v[136:139], v15 offset:0
ds_read_b128 v[140:143], v15 offset:32
s_waitcnt lgkmcnt(4)
v_mfma_f32_32x32x16_bf16 v[112:127], v[152:155], v[160:163], v[112:127]
v_mfma_f32_32x32x16_bf16 v[112:127], v[156:159], v[164:167], v[112:127]
ds_read_b128 v[152:155], v7 offset:2912
ds_read_b128 v[156:159], v7 offset:2880
v_add_u32 v15, 4294966256, v13
v_max_i32 v15, 0, v15
v_add_u32 v15, v15, v12
ds_read_b128 v[160:163], v15 offset:0
ds_read_b128 v[164:167], v15 offset:32
s_waitcnt lgkmcnt(4)
v_mfma_f32_32x32x16_bf16 v[112:127], v[128:131], v[136:139], v[112:127]
v_mfma_f32_32x32x16_bf16 v[112:127], v[132:135], v[140:143], v[112:127]
ds_read_b128 v[128:131], v7 offset:2976
ds_read_b128 v[132:135], v7 offset:2944
v_add_u32 v15, 4294966176, v13
v_max_i32 v15, 0, v15
v_add_u32 v15, v15, v12
ds_read_b128 v[136:139], v15 offset:0
ds_read_b128 v[140:143], v15 offset:32
s_waitcnt lgkmcnt(4)
v_mfma_f32_32x32x16_bf16 v[112:127], v[152:155], v[160:163], v[112:127]
v_mfma_f32_32x32x16_bf16 v[112:127], v[156:159], v[164:167], v[112:127]
ds_read_b128 v[152:155], v7 offset:3040
ds_read_b128 v[156:159], v7 offset:3008
v_add_u32 v15, 4294966096, v13
v_max_i32 v15, 0, v15
v_add_u32 v15, v15, v12
ds_read_b128 v[160:163], v15 offset:0
ds_read_b128 v[164:167], v15 offset:32
s_waitcnt lgkmcnt(4)
v_mfma_f32_32x32x16_bf16 v[112:127], v[128:131], v[136:139], v[112:127]
v_mfma_f32_32x32x16_bf16 v[112:127], v[132:135], v[140:143], v[112:127]
ds_read_b128 v[128:131], v7 offset:3104
ds_read_b128 v[132:135], v7 offset:3072
v_add_u32 v15, 4294966016, v13
v_max_i32 v15, 0, v15
v_add_u32 v15, v15, v12
ds_read_b128 v[136:139], v15 offset:0
ds_read_b128 v[140:143], v15 offset:32
s_waitcnt lgkmcnt(4)
v_mfma_f32_32x32x16_bf16 v[112:127], v[152:155], v[160:163], v[112:127]
v_mfma_f32_32x32x16_bf16 v[112:127], v[156:159], v[164:167], v[112:127]
ds_read_b128 v[152:155], v7 offset:3168
ds_read_b128 v[156:159], v7 offset:3136
v_add_u32 v15, 4294965936, v13
v_max_i32 v15, 0, v15
v_add_u32 v15, v15, v12
ds_read_b128 v[160:163], v15 offset:0
ds_read_b128 v[164:167], v15 offset:32
s_waitcnt lgkmcnt(4)
v_mfma_f32_32x32x16_bf16 v[112:127], v[128:131], v[136:139], v[112:127]
v_mfma_f32_32x32x16_bf16 v[112:127], v[132:135], v[140:143], v[112:127]
ds_read_b128 v[128:131], v7 offset:3232
ds_read_b128 v[132:135], v7 offset:3200
v_add_u32 v15, 4294965856, v13
v_max_i32 v15, 0, v15
v_add_u32 v15, v15, v12
ds_read_b128 v[136:139], v15 offset:0
ds_read_b128 v[140:143], v15 offset:32
s_waitcnt lgkmcnt(4)
v_mfma_f32_32x32x16_bf16 v[112:127], v[152:155], v[160:163], v[112:127]
v_mfma_f32_32x32x16_bf16 v[112:127], v[156:159], v[164:167], v[112:127]
ds_read_b128 v[152:155], v7 offset:3296
ds_read_b128 v[156:159], v7 offset:3264
v_add_u32 v15, 4294965776, v13
v_max_i32 v15, 0, v15
v_add_u32 v15, v15, v12
ds_read_b128 v[160:163], v15 offset:0
ds_read_b128 v[164:167], v15 offset:32
s_waitcnt lgkmcnt(4)
v_mfma_f32_32x32x16_bf16 v[112:127], v[128:131], v[136:139], v[112:127]
v_mfma_f32_32x32x16_bf16 v[112:127], v[132:135], v[140:143], v[112:127]
ds_read_b128 v[128:131], v7 offset:3360
ds_read_b128 v[132:135], v7 offset:3328
v_add_u32 v15, 4294965696, v13
v_max_i32 v15, 0, v15
v_add_u32 v15, v15, v12
ds_read_b128 v[136:139], v15 offset:0
ds_read_b128 v[140:143], v15 offset:32
s_waitcnt lgkmcnt(4)
v_mfma_f32_32x32x16_bf16 v[112:127], v[152:155], v[160:163], v[112:127]
v_mfma_f32_32x32x16_bf16 v[112:127], v[156:159], v[164:167], v[112:127]
ds_read_b128 v[152:155], v7 offset:3424
ds_read_b128 v[156:159], v7 offset:3392
v_add_u32 v15, 4294965616, v13
v_max_i32 v15, 0, v15
v_add_u32 v15, v15, v12
ds_read_b128 v[160:163], v15 offset:0
ds_read_b128 v[164:167], v15 offset:32
s_waitcnt lgkmcnt(4)
v_mfma_f32_32x32x16_bf16 v[112:127], v[128:131], v[136:139], v[112:127]
v_mfma_f32_32x32x16_bf16 v[112:127], v[132:135], v[140:143], v[112:127]
ds_read_b128 v[128:131], v7 offset:3488
ds_read_b128 v[132:135], v7 offset:3456
v_add_u32 v15, 4294965536, v13
v_max_i32 v15, 0, v15
v_add_u32 v15, v15, v12
ds_read_b128 v[136:139], v15 offset:0
ds_read_b128 v[140:143], v15 offset:32
s_waitcnt lgkmcnt(4)
v_mfma_f32_32x32x16_bf16 v[112:127], v[152:155], v[160:163], v[112:127]
v_mfma_f32_32x32x16_bf16 v[112:127], v[156:159], v[164:167], v[112:127]
ds_read_b128 v[152:155], v7 offset:3552
ds_read_b128 v[156:159], v7 offset:3520
v_add_u32 v15, 4294965456, v13
v_max_i32 v15, 0, v15
v_add_u32 v15, v15, v12
ds_read_b128 v[160:163], v15 offset:0
ds_read_b128 v[164:167], v15 offset:32
s_waitcnt lgkmcnt(4)
v_mfma_f32_32x32x16_bf16 v[112:127], v[128:131], v[136:139], v[112:127]
v_mfma_f32_32x32x16_bf16 v[112:127], v[132:135], v[140:143], v[112:127]
ds_read_b128 v[128:131], v7 offset:3616
ds_read_b128 v[132:135], v7 offset:3584
v_add_u32 v15, 4294965376, v13
v_max_i32 v15, 0, v15
v_add_u32 v15, v15, v12
ds_read_b128 v[136:139], v15 offset:0
ds_read_b128 v[140:143], v15 offset:32
s_waitcnt lgkmcnt(4)
v_mfma_f32_32x32x16_bf16 v[112:127], v[152:155], v[160:163], v[112:127]
v_mfma_f32_32x32x16_bf16 v[112:127], v[156:159], v[164:167], v[112:127]
ds_read_b128 v[152:155], v7 offset:3680
ds_read_b128 v[156:159], v7 offset:3648
v_add_u32 v15, 4294965296, v13
v_max_i32 v15, 0, v15
v_add_u32 v15, v15, v12
ds_read_b128 v[160:163], v15 offset:0
ds_read_b128 v[164:167], v15 offset:32
s_waitcnt lgkmcnt(4)
v_mfma_f32_32x32x16_bf16 v[112:127], v[128:131], v[136:139], v[112:127]
v_mfma_f32_32x32x16_bf16 v[112:127], v[132:135], v[140:143], v[112:127]
ds_read_b128 v[128:131], v7 offset:3744
ds_read_b128 v[132:135], v7 offset:3712
v_add_u32 v15, 4294965216, v13
v_max_i32 v15, 0, v15
v_add_u32 v15, v15, v12
ds_read_b128 v[136:139], v15 offset:0
ds_read_b128 v[140:143], v15 offset:32
s_waitcnt lgkmcnt(4)
v_mfma_f32_32x32x16_bf16 v[112:127], v[152:155], v[160:163], v[112:127]
v_mfma_f32_32x32x16_bf16 v[112:127], v[156:159], v[164:167], v[112:127]
ds_read_b128 v[152:155], v7 offset:3808
ds_read_b128 v[156:159], v7 offset:3776
v_add_u32 v15, 4294965136, v13
v_max_i32 v15, 0, v15
v_add_u32 v15, v15, v12
ds_read_b128 v[160:163], v15 offset:0
ds_read_b128 v[164:167], v15 offset:32
s_waitcnt lgkmcnt(4)
v_mfma_f32_32x32x16_bf16 v[112:127], v[128:131], v[136:139], v[112:127]
v_mfma_f32_32x32x16_bf16 v[112:127], v[132:135], v[140:143], v[112:127]
ds_read_b128 v[128:131], v7 offset:3872
ds_read_b128 v[132:135], v7 offset:3840
v_add_u32 v15, 4294965056, v13
v_max_i32 v15, 0, v15
v_add_u32 v15, v15, v12
ds_read_b128 v[136:139], v15 offset:0
ds_read_b128 v[140:143], v15 offset:32
s_waitcnt lgkmcnt(4)
v_mfma_f32_32x32x16_bf16 v[112:127], v[152:155], v[160:163], v[112:127]
v_mfma_f32_32x32x16_bf16 v[112:127], v[156:159], v[164:167], v[112:127]
ds_read_b128 v[152:155], v7 offset:3936
ds_read_b128 v[156:159], v7 offset:3904
v_add_u32 v15, 4294964976, v13
v_max_i32 v15, 0, v15
v_add_u32 v15, v15, v12
ds_read_b128 v[160:163], v15 offset:0
ds_read_b128 v[164:167], v15 offset:32
s_waitcnt lgkmcnt(4)
v_mfma_f32_32x32x16_bf16 v[112:127], v[128:131], v[136:139], v[112:127]
v_mfma_f32_32x32x16_bf16 v[112:127], v[132:135], v[140:143], v[112:127]
ds_read_b128 v[128:131], v7 offset:4000
ds_read_b128 v[132:135], v7 offset:3968
v_add_u32 v15, 4294964896, v13
v_max_i32 v15, 0, v15
v_add_u32 v15, v15, v12
ds_read_b128 v[136:139], v15 offset:0
ds_read_b128 v[140:143], v15 offset:32
s_waitcnt lgkmcnt(4)
v_mfma_f32_32x32x16_bf16 v[112:127], v[152:155], v[160:163], v[112:127]
v_mfma_f32_32x32x16_bf16 v[112:127], v[156:159], v[164:167], v[112:127]
ds_read_b128 v[152:155], v7 offset:4064
ds_read_b128 v[156:159], v7 offset:4032
v_add_u32 v15, 4294964816, v13
v_max_i32 v15, 0, v15
v_add_u32 v15, v15, v12
ds_read_b128 v[160:163], v15 offset:0
ds_read_b128 v[164:167], v15 offset:32
s_waitcnt lgkmcnt(4)
v_mfma_f32_32x32x16_bf16 v[112:127], v[128:131], v[136:139], v[112:127]
v_mfma_f32_32x32x16_bf16 v[112:127], v[132:135], v[140:143], v[112:127]
s_waitcnt lgkmcnt(0)
v_mfma_f32_32x32x16_bf16 v[112:127], v[152:155], v[160:163], v[112:127]
v_mfma_f32_32x32x16_bf16 v[112:127], v[156:159], v[164:167], v[112:127]
s_nop 15
s_nop 3
v_lshlrev_b32 v4, 16, v4
s_add_u32 s12, s6, 8388608
s_addc_u32 s13, s7, 0
s_lshl_b32 s23, s21, 12
s_add_u32 s12, s12, s23
s_addc_u32 s13, s13, 0
s_mov_b32 s28, s12
s_mov_b32 s29, s13
s_mov_b32 s30, 4096
s_mov_b32 s31, 0x00020000
v_lshrrev_b32 v1, 5, v2
v_and_b32 v3, 31, v2
v_lshlrev_b32 v5, 6, v3
v_lshlrev_b32 v6, 3, v1
v_add_u32 v5, v5, v6
v_sub_u32 v6, 1, v1
v_lshlrev_b32 v6, 3, v6
v_add_u32 v6, v6, v13
v_add_u32 v6, 34048, v6
v_add_u32 v6, s36, v6
ds_read_b64 v[16:17], v6 offset:0
ds_read_b64 v[18:19], v6 offset:16
ds_read_b64 v[20:21], v6 offset:32
ds_read_b64 v[22:23], v6 offset:48
s_waitcnt lgkmcnt(0)
v_and_b32 v30, 0xffff0000, v17
v_lshlrev_b32 v31, 16, v17
v_and_b32 v32, 0xffff0000, v16
v_lshlrev_b32 v33, 16, v16
v_mul_f32 v30, v30, v4
v_mul_f32 v31, v31, v4
v_mul_f32 v32, v32, v4
v_mul_f32 v33, v33, v4
v_cvt_pk_bf16_f32 v34, v30, v31
v_cvt_pk_bf16_f32 v35, v32, v33
v_cvt_pk_bf16_f32 v36, v96, v97
v_cvt_pk_bf16_f32 v37, v98, v99
v_lshlrev_b32 v30, 16, v34
v_and_b32 v31, 0xffff0000, v34
v_lshlrev_b32 v32, 16, v35
v_and_b32 v33, 0xffff0000, v35
v_lshlrev_b32 v38, 16, v36
v_and_b32 v39, 0xffff0000, v36
v_lshlrev_b32 v40, 16, v37
v_and_b32 v41, 0xffff0000, v37
v_add_f32 v30, v30, v38
v_add_f32 v31, v31, v39
v_add_f32 v32, v32, v40
v_add_f32 v33, v33, v41
v_cvt_pk_bf16_f32 v44, v30, v31
v_cvt_pk_bf16_f32 v45, v32, v33
v_and_b32 v30, 0xffff0000, v19
v_lshlrev_b32 v31, 16, v19
v_and_b32 v32, 0xffff0000, v18
v_lshlrev_b32 v33, 16, v18
v_mul_f32 v30, v30, v4
v_mul_f32 v31, v31, v4
v_mul_f32 v32, v32, v4
v_mul_f32 v33, v33, v4
v_cvt_pk_bf16_f32 v34, v30, v31
v_cvt_pk_bf16_f32 v35, v32, v33
v_cvt_pk_bf16_f32 v36, v100, v101
v_cvt_pk_bf16_f32 v37, v102, v103
v_lshlrev_b32 v30, 16, v34
v_and_b32 v31, 0xffff0000, v34
v_lshlrev_b32 v32, 16, v35
v_and_b32 v33, 0xffff0000, v35
v_lshlrev_b32 v38, 16, v36
v_and_b32 v39, 0xffff0000, v36
v_lshlrev_b32 v40, 16, v37
v_and_b32 v41, 0xffff0000, v37
v_add_f32 v30, v30, v38
v_add_f32 v31, v31, v39
v_add_f32 v32, v32, v40
v_add_f32 v33, v33, v41
v_cvt_pk_bf16_f32 v46, v30, v31
v_cvt_pk_bf16_f32 v47, v32, v33
v_and_b32 v30, 0xffff0000, v21
v_lshlrev_b32 v31, 16, v21
v_and_b32 v32, 0xffff0000, v20
v_lshlrev_b32 v33, 16, v20
v_mul_f32 v30, v30, v4
v_mul_f32 v31, v31, v4
v_mul_f32 v32, v32, v4
v_mul_f32 v33, v33, v4
v_cvt_pk_bf16_f32 v34, v30, v31
v_cvt_pk_bf16_f32 v35, v32, v33
v_cvt_pk_bf16_f32 v36, v104, v105
v_cvt_pk_bf16_f32 v37, v106, v107
v_lshlrev_b32 v30, 16, v34
v_and_b32 v31, 0xffff0000, v34
v_lshlrev_b32 v32, 16, v35
v_and_b32 v33, 0xffff0000, v35
v_lshlrev_b32 v38, 16, v36
v_and_b32 v39, 0xffff0000, v36
v_lshlrev_b32 v40, 16, v37
v_and_b32 v41, 0xffff0000, v37
v_add_f32 v30, v30, v38
v_add_f32 v31, v31, v39
v_add_f32 v32, v32, v40
v_add_f32 v33, v33, v41
v_cvt_pk_bf16_f32 v48, v30, v31
v_cvt_pk_bf16_f32 v49, v32, v33
v_and_b32 v30, 0xffff0000, v23
v_lshlrev_b32 v31, 16, v23
v_and_b32 v32, 0xffff0000, v22
v_lshlrev_b32 v33, 16, v22
v_mul_f32 v30, v30, v4
v_mul_f32 v31, v31, v4
v_mul_f32 v32, v32, v4
v_mul_f32 v33, v33, v4
v_cvt_pk_bf16_f32 v34, v30, v31
v_cvt_pk_bf16_f32 v35, v32, v33
v_cvt_pk_bf16_f32 v36, v108, v109
v_cvt_pk_bf16_f32 v37, v110, v111
v_lshlrev_b32 v30, 16, v34
v_and_b32 v31, 0xffff0000, v34
v_lshlrev_b32 v32, 16, v35
v_and_b32 v33, 0xffff0000, v35
v_lshlrev_b32 v38, 16, v36
v_and_b32 v39, 0xffff0000, v36
v_lshlrev_b32 v40, 16, v37
v_and_b32 v41, 0xffff0000, v37
v_add_f32 v30, v30, v38
v_add_f32 v31, v31, v39
v_add_f32 v32, v32, v40
v_add_f32 v33, v33, v41
v_cvt_pk_bf16_f32 v50, v30, v31
v_cvt_pk_bf16_f32 v51, v32, v33
buffer_store_dwordx2 v[44:45], v5, s[28:31], 0 offen offset:0
buffer_store_dwordx2 v[46:47], v5, s[28:31], 0 offen offset:16
buffer_store_dwordx2 v[48:49], v5, s[28:31], 0 offen offset:32
buffer_store_dwordx2 v[50:51], v5, s[28:31], 0 offen offset:48
s_nop 1
ds_read_b64 v[16:17], v6 offset:2560
ds_read_b64 v[18:19], v6 offset:2576
ds_read_b64 v[20:21], v6 offset:2592
ds_read_b64 v[22:23], v6 offset:2608
s_waitcnt lgkmcnt(0)
v_and_b32 v30, 0xffff0000, v17
v_lshlrev_b32 v31, 16, v17
v_and_b32 v32, 0xffff0000, v16
v_lshlrev_b32 v33, 16, v16
v_mul_f32 v30, v30, v4
v_mul_f32 v31, v31, v4
v_mul_f32 v32, v32, v4
v_mul_f32 v33, v33, v4
v_cvt_pk_bf16_f32 v34, v30, v31
v_cvt_pk_bf16_f32 v35, v32, v33
v_cvt_pk_bf16_f32 v36, v112, v113
v_cvt_pk_bf16_f32 v37, v114, v115
v_lshlrev_b32 v30, 16, v34
v_and_b32 v31, 0xffff0000, v34
v_lshlrev_b32 v32, 16, v35
v_and_b32 v33, 0xffff0000, v35
v_lshlrev_b32 v38, 16, v36
v_and_b32 v39, 0xffff0000, v36
v_lshlrev_b32 v40, 16, v37
v_and_b32 v41, 0xffff0000, v37
v_add_f32 v30, v30, v38
v_add_f32 v31, v31, v39
v_add_f32 v32, v32, v40
v_add_f32 v33, v33, v41
v_cvt_pk_bf16_f32 v44, v30, v31
v_cvt_pk_bf16_f32 v45, v32, v33
v_and_b32 v30, 0xffff0000, v19
v_lshlrev_b32 v31, 16, v19
v_and_b32 v32, 0xffff0000, v18
v_lshlrev_b32 v33, 16, v18
v_mul_f32 v30, v30, v4
v_mul_f32 v31, v31, v4
v_mul_f32 v32, v32, v4
v_mul_f32 v33, v33, v4
v_cvt_pk_bf16_f32 v34, v30, v31
v_cvt_pk_bf16_f32 v35, v32, v33
v_cvt_pk_bf16_f32 v36, v116, v117
v_cvt_pk_bf16_f32 v37, v118, v119
v_lshlrev_b32 v30, 16, v34
v_and_b32 v31, 0xffff0000, v34
v_lshlrev_b32 v32, 16, v35
v_and_b32 v33, 0xffff0000, v35
v_lshlrev_b32 v38, 16, v36
v_and_b32 v39, 0xffff0000, v36
v_lshlrev_b32 v40, 16, v37
v_and_b32 v41, 0xffff0000, v37
v_add_f32 v30, v30, v38
v_add_f32 v31, v31, v39
v_add_f32 v32, v32, v40
v_add_f32 v33, v33, v41
v_cvt_pk_bf16_f32 v46, v30, v31
v_cvt_pk_bf16_f32 v47, v32, v33
v_and_b32 v30, 0xffff0000, v21
v_lshlrev_b32 v31, 16, v21
v_and_b32 v32, 0xffff0000, v20
v_lshlrev_b32 v33, 16, v20
v_mul_f32 v30, v30, v4
v_mul_f32 v31, v31, v4
v_mul_f32 v32, v32, v4
v_mul_f32 v33, v33, v4
v_cvt_pk_bf16_f32 v34, v30, v31
v_cvt_pk_bf16_f32 v35, v32, v33
v_cvt_pk_bf16_f32 v36, v120, v121
v_cvt_pk_bf16_f32 v37, v122, v123
v_lshlrev_b32 v30, 16, v34
v_and_b32 v31, 0xffff0000, v34
v_lshlrev_b32 v32, 16, v35
v_and_b32 v33, 0xffff0000, v35
v_lshlrev_b32 v38, 16, v36
v_and_b32 v39, 0xffff0000, v36
v_lshlrev_b32 v40, 16, v37
v_and_b32 v41, 0xffff0000, v37
v_add_f32 v30, v30, v38
v_add_f32 v31, v31, v39
v_add_f32 v32, v32, v40
v_add_f32 v33, v33, v41
v_cvt_pk_bf16_f32 v48, v30, v31
v_cvt_pk_bf16_f32 v49, v32, v33
v_and_b32 v30, 0xffff0000, v23
v_lshlrev_b32 v31, 16, v23
v_and_b32 v32, 0xffff0000, v22
v_lshlrev_b32 v33, 16, v22
v_mul_f32 v30, v30, v4
v_mul_f32 v31, v31, v4
v_mul_f32 v32, v32, v4
v_mul_f32 v33, v33, v4
v_cvt_pk_bf16_f32 v34, v30, v31
v_cvt_pk_bf16_f32 v35, v32, v33
v_cvt_pk_bf16_f32 v36, v124, v125
v_cvt_pk_bf16_f32 v37, v126, v127
v_lshlrev_b32 v30, 16, v34
v_and_b32 v31, 0xffff0000, v34
v_lshlrev_b32 v32, 16, v35
v_and_b32 v33, 0xffff0000, v35
v_lshlrev_b32 v38, 16, v36
v_and_b32 v39, 0xffff0000, v36
v_lshlrev_b32 v40, 16, v37
v_and_b32 v41, 0xffff0000, v37
v_add_f32 v30, v30, v38
v_add_f32 v31, v31, v39
v_add_f32 v32, v32, v40
v_add_f32 v33, v33, v41
v_cvt_pk_bf16_f32 v50, v30, v31
v_cvt_pk_bf16_f32 v51, v32, v33
buffer_store_dwordx2 v[44:45], v5, s[28:31], 0 offen offset:2048
buffer_store_dwordx2 v[46:47], v5, s[28:31], 0 offen offset:2064
buffer_store_dwordx2 v[48:49], v5, s[28:31], 0 offen offset:2080
buffer_store_dwordx2 v[50:51], v5, s[28:31], 0 offen offset:2096
s_nop 1
C_end:
s_endpgm
.globl outp_kernel
.p2align 8
.type outp_kernel,@function
outp_kernel:
s_cmp_ge_u32 s2, 512
s_cbranch_scc1 O_end
s_lshr_b32 s22, s2, 4
s_and_b32 s23, s2, 15
s_lshl_b32 s22, s22, 6
s_lshl_b32 s23, s23, 6
s_load_dwordx2 s[4:5], s[0:1], 56
s_load_dwordx2 s[6:7], s[0:1], 104
s_load_dwordx2 s[8:9], s[0:1], 120
s_waitcnt lgkmcnt(0)
s_add_u32 s8, s8, 8388608
s_addc_u32 s9, s9, 0
s_mov_b32 s24, s4
s_mov_b32 s25, s5
s_mov_b32 s26, 2097152
s_mov_b32 s27, 0x00020000
s_mov_b32 s28, s6
s_mov_b32 s29, s7
s_mov_b32 s30, 4194304
s_mov_b32 s31, 0x00020000
s_mov_b32 s32, s8
s_mov_b32 s33, s9
s_mov_b32 s34, 4194304
s_mov_b32 s35, 0x00020000
v_lshrrev_b32 v1, 2, v0
v_and_b32 v2, 3, v0
v_add_u32 v3, s23, v1
v_lshlrev_b32 v3, 12, v3
v_lshlrev_b32 v4, 5, v2
v_add_u32 v3, v3, v4
s_lshl_b32 s36, s22, 1
v_add_u32 v3, s36, v3
buffer_load_dwordx4 v[16:19], v3, s[32:35], 0 offen
buffer_load_dwordx4 v[20:23], v3, s[32:35], 0 offen offset:16
v_add_u32 v5, s22, v1
v_lshlrev_b32 v5, 10, v5
v_add_u32 v5, v5, v4
s_sub_u32 s36, s23, 512
s_lshl_b32 s36, s36, 1
v_add_u32 v5, s36, v5
buffer_load_dwordx4 v[40:43], v5, s[24:27], 0 offen
buffer_load_dwordx4 v[44:47], v5, s[24:27], 0 offen offset:16
s_waitcnt vmcnt(0)
v_mul_u32_u24 v6, 2304, v2
v_lshlrev_b32 v7, 1, v1
v_add_u32 v6, v6, v7
ds_write_b16 v6, v16 offset:0
ds_write_b16_d16_hi v6, v16 offset:144
ds_write_b16 v6, v17 offset:288
ds_write_b16_d16_hi v6, v17 offset:432
ds_write_b16 v6, v18 offset:576
ds_write_b16_d16_hi v6, v18 offset:720
ds_write_b16 v6, v19 offset:864
ds_write_b16_d16_hi v6, v19 offset:1008
ds_write_b16 v6, v20 offset:1152
ds_write_b16_d16_hi v6, v20 offset:1296
ds_write_b16 v6, v21 offset:1440
ds_write_b16_d16_hi v6, v21 offset:1584
ds_write_b16 v6, v22 offset:1728
ds_write_b16_d16_hi v6, v22 offset:1872
ds_write_b16 v6, v23 offset:2016
ds_write_b16_d16_hi v6, v23 offset:2160
s_waitcnt lgkmcnt(0)
s_barrier
v_mul_u32_u24 v6, 144, v1
v_add_u32 v6, v6, v4
ds_read_b128 v[16:19], v6
ds_read_b128 v[20:23], v6 offset:16
s_waitcnt lgkmcnt(0)
s_cmp_lt_u32 s23, 512
s_cbranch_scc1 O_st
v_lshlrev_b32 v30, 16, v16
v_and_b32 v31, 0xffff0000, v16
v_lshlrev_b32 v32, 16, v40
v_and_b32 v33, 0xffff0000, v40
v_mul_f32 v30, v30, v32
v_mul_f32 v31, v31, v33
v_cvt_pk_bf16_f32 v16, v30, v31
v_lshlrev_b32 v30, 16, v17
v_and_b32 v31, 0xffff0000, v17
v_lshlrev_b32 v32, 16, v41
v_and_b32 v33, 0xffff0000, v41
v_mul_f32 v30, v30, v32
v_mul_f32 v31, v31, v33
v_cvt_pk_bf16_f32 v17, v30, v31
v_lshlrev_b32 v30, 16, v18
v_and_b32 v31, 0xffff0000, v18
v_lshlrev_b32 v32, 16, v42
v_and_b32 v33, 0xffff0000, v42
v_mul_f32 v30, v30, v32
v_mul_f32 v31, v31, v33
v_cvt_pk_bf16_f32 v18, v30, v31
v_lshlrev_b32 v30, 16, v19
v_and_b32 v31, 0xffff0000, v19
v_lshlrev_b32 v32, 16, v43
v_and_b32 v33, 0xffff0000, v43
v_mul_f32 v30, v30, v32
v_mul_f32 v31, v31, v33
v_cvt_pk_bf16_f32 v19, v30, v31
v_lshlrev_b32 v30, 16, v20
v_and_b32 v31, 0xffff0000, v20
v_lshlrev_b32 v32, 16, v44
v_and_b32 v33, 0xffff0000, v44
v_mul_f32 v30, v30, v32
v_mul_f32 v31, v31, v33
v_cvt_pk_bf16_f32 v20, v30, v31
v_lshlrev_b32 v30, 16, v21
v_and_b32 v31, 0xffff0000, v21
v_lshlrev_b32 v32, 16, v45
v_and_b32 v33, 0xffff0000, v45
v_mul_f32 v30, v30, v32
v_mul_f32 v31, v31, v33
v_cvt_pk_bf16_f32 v21, v30, v31
v_lshlrev_b32 v30, 16, v22
v_and_b32 v31, 0xffff0000, v22
v_lshlrev_b32 v32, 16, v46
v_and_b32 v33, 0xffff0000, v46
v_mul_f32 v30, v30, v32
v_mul_f32 v31, v31, v33
v_cvt_pk_bf16_f32 v22, v30, v31
v_lshlrev_b32 v30, 16, v23
v_and_b32 v31, 0xffff0000, v23
v_lshlrev_b32 v32, 16, v47
v_and_b32 v33, 0xffff0000, v47
v_mul_f32 v30, v30, v32
v_mul_f32 v31, v31, v33
v_cvt_pk_bf16_f32 v23, v30, v31
O_st:
v_add_u32 v5, s22, v1
v_lshlrev_b32 v5, 11, v5
v_add_u32 v5, v5, v4
s_lshl_b32 s36, s23, 1
v_add_u32 v5, s36, v5
buffer_store_dwordx4 v[16:19], v5, s[28:31], 0 offen
buffer_store_dwordx4 v[20:23], v5, s[28:31], 0 offen offset:16
O_end:
s_endpgm
.section .rodata,"a"
.p2align 6
.amdhsa_kernel prep_kernel
  .amdhsa_next_free_vgpr 128
  .amdhsa_next_free_sgpr 102
  .amdhsa_accum_offset 128
  .amdhsa_group_segment_fixed_size 0
  .amdhsa_kernarg_size 128
  .amdhsa_user_sgpr_count 2
  .amdhsa_user_sgpr_kernarg_segment_ptr 1
  .amdhsa_system_sgpr_workgroup_id_x 1
.end_amdhsa_kernel
.amdhsa_kernel conv_kernel
  .amdhsa_next_free_vgpr 176
  .amdhsa_next_free_sgpr 102
  .amdhsa_accum_offset 176
  .amdhsa_group_segment_fixed_size 0
  .amdhsa_kernarg_size 128
  .amdhsa_user_sgpr_count 2
  .amdhsa_user_sgpr_kernarg_segment_ptr 1
  .amdhsa_system_sgpr_workgroup_id_x 1
.end_amdhsa_kernel
.amdhsa_kernel outp_kernel
  .amdhsa_next_free_vgpr 48
  .amdhsa_next_free_sgpr 102
  .amdhsa_accum_offset 48
  .amdhsa_group_segment_fixed_size 0
  .amdhsa_kernarg_size 128
  .amdhsa_user_sgpr_count 2
  .amdhsa_user_sgpr_kernarg_segment_ptr 1
  .amdhsa_system_sgpr_workgroup_id_x 1
.end_amdhsa_kernel
```
